```python
import torch

def _softmax(x, axis=-1):
    return torch.softmax(x, dim=axis)
def _gelu(x):
    return torch.nn.functional.gelu(x, approximate="tanh")
def _silu(x):
    return torch.nn.functional.silu(x)
def _sigmoid(x):
    return torch.sigmoid(x)
def _layernorm(x, axis=-1, eps=1e-5):
    m = x.mean(dim=axis, keepdim=True)
    v = x.var(dim=axis, keepdim=True, unbiased=False)
    return (x - m) / torch.sqrt(v + eps)
def _scatter_add(tgt, idx, src, axis=0):
    return tgt.clone().index_add_(axis, idx, src)
def _segment_sum(src, seg, n):
    out = torch.zeros((n,) + src.shape[1:], dtype=src.dtype)
    return out.index_add_(0, seg, src)
def _pad(x, pw):
    flat = tuple(v for pair in reversed(pw) for v in pair)
    return torch.nn.functional.pad(x, flat)

kernel_name = 'interleave_layers__sliding_block_cached__dense_activation_gelu__decode'

def setup_inputs():

    _w = (lambda a: (lambda t: t.to(torch.bfloat16) if t.is_floating_point() else t)(torch.as_tensor(a)))
    def _A_setup():
        B, Sq, D = 2, 1, 576
        Hq, Hkv, Sk, Dh = 32, 16, 4096, 128
        assert Hq % Hkv == 0, (Hq, Hkv)
        return {
            "x": _w((lambda *s: torch.randn(*s, dtype=torch.bfloat16) * 0.05)(B, Sq, D)),
            "k_cache": _w((lambda *s: torch.randn(*s, dtype=torch.bfloat16) * 1.6)(B, Hkv, Sk, Dh)),
            "v_cache": _w((lambda *s: torch.randn(*s, dtype=torch.bfloat16) * 0.4)(B, Hkv, Sk, Dh)),
            "wq": _w((lambda *s: torch.randn(*s, dtype=torch.bfloat16) * 1.6)(D, Hq * Dh) * (D ** -0.5)),
            "wo": _w((lambda *s: torch.randn(*s, dtype=torch.bfloat16) * 0.4)(Hq * Dh, D) * ((Hq * Dh) ** -0.5)),
        }
    _A_in = _A_setup()

    def _B_setup():
        B, S, D, F = 2, 1, 576, 4608
        return {
            "x": _w((lambda *s: torch.randn(*s, dtype=torch.bfloat16) * 0.05)(B, S, D)),
            "w1": _w((lambda *s: torch.randn(*s, dtype=torch.bfloat16) * 0.4)(D, F) * (D ** -0.5)),
            "b1": _w((lambda *s: torch.randn(*s, dtype=torch.bfloat16) * 12.8)(F) * 0.01),
            "w2": _w((lambda *s: torch.randn(*s, dtype=torch.bfloat16) * 0.2)(F, D) * (F ** -0.5)),
            "b2": _w((lambda *s: torch.randn(*s, dtype=torch.bfloat16) * 0.8)(D) * 0.01),
        }
    _B_in = _B_setup()

    return {
        "A_x": _A_in["x"],
        "A_k_cache": _A_in["k_cache"],
        "A_v_cache": _A_in["v_cache"],
        "A_wq": _A_in["wq"],
        "A_wo": _A_in["wo"],
        "B_x": _B_in["x"],
        "B_w1": _B_in["w1"],
        "B_b1": _B_in["b1"],
        "B_w2": _B_in["w2"],
        "B_b2": _B_in["b2"],
    }

def reference(A_x, A_k_cache, A_v_cache, A_wq, A_wo, B_x, B_w1, B_b1, B_w2, B_b2):
    def _A_ref(x, k_cache, v_cache, wq, wo):
        B, Sq, D = x.shape
        Hq, Dh = 32, 128
        Hkv, Sk = k_cache.shape[1], k_cache.shape[2]
        W = min(4096, max(256, Sk // 4))
        rep = Hq // Hkv
        q = (lambda x, *d: x.permute(*d))((x @ wq).reshape(B, Sq, Hq, Dh), 0, 2, 1, 3)
        k = (lambda x, n, axis: torch.repeat_interleave(x, n, dim=axis))(k_cache[:, :, Sk - W:, :], rep, axis=1)
        v = (lambda x, n, axis: torch.repeat_interleave(x, n, dim=axis))(v_cache[:, :, Sk - W:, :], rep, axis=1)
        scores = torch.einsum("bhqd,bhkd->bhqk", q, k) * (Dh ** -0.5)
        p = _softmax(scores, axis=-1)
        o = torch.einsum("bhqk,bhkd->bhqd", p, v)
        return (lambda x, *d: x.permute(*d))(o, 0, 2, 1, 3).reshape(B, Sq, Hq * Dh) @ wo

    def _B_ref(x, w1, b1, w2, b2):
        h = torch.einsum("bsd,df->bsf", x, w1) + b1
        h = _gelu(h)
        return torch.einsum("bsf,fd->bsd", h, w2) + b2

    x = A_x
    x = x + _A_ref(_layernorm(x, axis=-1), A_k_cache, A_v_cache, A_wq, A_wo)
    x = x + _B_ref(_layernorm(x, axis=-1), B_w1, B_b1, B_w2, B_b2)
    x = x + _A_ref(_layernorm(x, axis=-1), A_k_cache, A_v_cache, A_wq, A_wo)
    x = x + _B_ref(_layernorm(x, axis=-1), B_w1, B_b1, B_w2, B_b2)
    return x
```

```asm
; @launch grid=(256,1,1) block=(640,1,1) lds=155136
.amdgcn_target "amdgcn-amd-amdhsa--gfx950"
.text
.globl interleave_layers__sliding_block_cached__dense_activation_gelu__decode_kernel
.p2align 8
.type interleave_layers__sliding_block_cached__dense_activation_gelu__decode_kernel,@function
interleave_layers__sliding_block_cached__dense_activation_gelu__decode_kernel:
    s_cmp_ge_u32 s2, 256
    s_cbranch_scc1 L_END
    s_load_dwordx16 s[24:39], s[0:1], 0
    s_load_dwordx8 s[40:47], s[0:1], 64
    s_load_dwordx2 s[72:73], s[0:1], 96
    v_lshrrev_b32 v4, 6, v0
    v_and_b32 v1, 63, v0
    v_readfirstlane_b32 s74, v4
    v_and_b32 v2, 15, v0
    v_lshrrev_b32 v3, 4, v1
    s_and_b32 s76, s2, 7
    s_lshr_b32 s77, s2, 3
    s_lshr_b32 s78, s77, 3
    s_and_b32 s79, s77, 7
    s_bfe_u32 s89, s77, 0x10003
    s_cmp_lg_u32 s74, 0
    s_cbranch_scc1 W_START
    s_setprio 3
    s_getpc_b64 s[100:101]
L_PC:
    s_lshl_b32 s85, s77, 7
    v_lshl_add_u32 v162, v1, 12, s85
    v_min_u32 v162, L_CODE_END-L_PC, v162
    s_mov_b64 exec, 0x3ff
    global_load_dword v163, v162, s[100:101]
    s_mov_b64 exec, -1
    v_mul_u32_u24 v4, 57, v1
    v_lshrrev_b32 v4, 9, v4
    v_mul_u32_u24 v5, 9, v4
    v_sub_u32 v5, v1, v5
    v_min_u32 v6, 7, v5
    v_lshlrev_b32 v6, 4, v6
    v_lshl_add_u32 v136, v4, 13, v6
    v_add_u32 v137, 56336, v136
    v_add_u32 v138, 112672, v136
    s_mul_i32 s81, s78, 1179648
    s_lshl_b32 s85, s76, 10
    s_add_u32 s81, s81, s85
    s_lshl_b32 s85, s79, 7
    s_add_u32 s81, s81, s85
    s_mov_b32 s58, 4718592
    s_mov_b32 s59, 0x20000
    s_waitcnt lgkmcnt(0)
    s_mov_b32 s56, s30
    s_and_b32 s57, s31, 0xffff
    s_mov_b32 m0, 0
LT_1:
    s_nop 0
    buffer_load_dwordx4 v136, s[56:59], s81 offen offset:0 nt lds
    buffer_load_dwordx4 v137, s[56:59], s81 offen offset:1008 nt lds
    buffer_load_dwordx4 v138, s[56:59], s81 offen offset:2016 nt lds
    s_add_u32 s81, s81, 172032
    s_add_u32 m0, m0, 3024
    s_cmp_lt_u32 m0, 21168
    s_cbranch_scc1 LT_1
    v_xor_b32 v6, v2, v3
    v_lshlrev_b32 v6, 4, v6
    v_lshl_add_u32 v130, v3, 8, v6
    v_add_u32 v130, 4096, v130
    v_xor_b32 v131, 64, v130
    v_add_u32 v131, 7168, v131
    v_xor_b32 v132, 128, v130
    v_add_u32 v132, 14336, v132
    v_xor_b32 v133, 192, v130
    v_add_u32 v133, 21504, v133
    s_lshl_b32 s85, s89, 4
    s_lshl_b32 s86, s76, 1
    s_add_u32 s85, s85, s86
    s_lshr_b32 s86, s77, 4
    s_add_u32 s85, s85, s86
    s_lshl_b32 s85, s85, 20
    s_lshl_b32 s86, s79, 10
    s_add_u32 s85, s85, s86
    s_add_u32 s82, s85, 782336
    s_mov_b32 s75, s82
    s_mov_b32 s48, s26
    s_and_b32 s49, s27, 0xffff
    s_mov_b32 s50, 33554432
    s_mov_b32 s51, 0x20000
    v_lshlrev_b32 v5, 4, v5
    v_mul_u32_u24 v139, 9216, v4
    v_add_u32 v139, v139, v5
    v_mul_u32_u24 v142, 1152, v4
    v_add_u32 v142, v142, v5
    v_add_u32 v140, 63504, v139
    v_add_u32 v141, 127008, v139
    v_add_u32 v143, 7056, v142
    v_add_u32 v144, 14112, v142
    v_lshlrev_b32 v5, 1, v3
    v_xor_b32 v5, v5, v2
    v_lshlrev_b32 v5, 4, v5
    v_lshl_add_u32 v146, v3, 8, v5
    v_add_u32 v146, 4096, v146
    v_add_u32 v147, 7168, v146
    v_xor_b32 v148, 128, v146
    v_add_u32 v148, 14336, v148
    v_add_u32 v149, 7168, v148
    s_mov_b32 s52, s28
    s_and_b32 s53, s29, 0xffff
    s_mov_b32 s54, 33554432
    s_mov_b32 s55, 0x20000
    s_mov_b32 s60, s36
    s_and_b32 s61, s37, 0xffff
    s_mov_b32 s62, 5308416
    s_mov_b32 s63, 0x20000
    s_mul_i32 s80, s78, 1327104
    s_mul_i32 s85, s76, 1152
    s_add_u32 s80, s80, s85
    s_mul_i32 s87, s79, 144
    s_add_u32 s80, s80, s87
    s_lshl_b32 s86, s76, 1
    s_add_u32 s88, s86, s89
    s_mov_b32 s85, 331776
    s_mov_b32 s66, 5308416
    s_cmp_lt_u32 s77, 16
    s_cselect_b32 s85, 294912, s85
    s_cselect_b32 s66, 4718592, s66
    s_cselect_b32 s64, s32, s40
    s_cselect_b32 s65, s33, s41
    s_and_b32 s65, s65, 0xffff
    s_mov_b32 s67, 0x20000
    s_mul_i32 s84, s88, s85
    s_add_u32 s84, s84, s87
    s_mov_b32 m0, 111616
LT_2:
    s_nop 0
    buffer_load_dwordx4 v142, s[64:67], s84 offen offset:0 nt lds
    buffer_load_dwordx4 v143, s[64:67], s84 offen offset:1008 nt lds
    buffer_load_dwordx4 v144, s[64:67], s84 offen offset:2016 nt lds
    s_add_u32 s84, s84, 24192
    s_add_u32 m0, m0, 3024
    s_cmp_lt_u32 m0, 120688
    s_cbranch_scc1 LT_2
    v_lshlrev_b32 v129, 4, v1
    v_add_u32 v6, 832, v129
    v_cmp_lt_u32 vcc, 19, v1
    s_mov_b32 s68, s24
    s_and_b32 s69, s25, 0xffff
    s_mov_b32 s70, 2304
    s_mov_b32 s71, 0x20000
    v_cndmask_b32 v129, v129, v6, vcc
    s_mul_i32 s88, s78, 288
    s_mov_b32 m0, 42496
    s_mov_b32 exec_hi, 0xff
    buffer_load_dwordx4 v129, s[68:71], s88 offen lds
    s_mov_b32 s20, s42
    s_and_b32 s21, s43, 0xffff
    s_mov_b32 s22, 1152
    s_mov_b32 s23, 0x20000
    s_mov_b32 s16, s38
    s_and_b32 s17, s39, 0xffff
    s_mov_b32 s18, 9216
    s_mov_b32 s19, 0x20000
    v_lshlrev_b32 v129, 4, v1
    s_mov_b32 m0, 154432
    s_lshl_b32 s85, s76, 1
    s_add_u32 s85, s85, s89
    s_mul_i32 s85, s85, 576
    buffer_load_dwordx4 v129, s[16:19], s85 offen nt lds
    s_mov_b32 m0, 154112
    s_mov_b64 exec, 0xfffff
    buffer_load_dwordx4 v129, s[20:23], s88 offen lds
    s_mov_b64 exec, -1
    s_cmp_lt_u32 s77, 16
    s_cbranch_scc0 LD_M
    s_mov_b32 m0, 120688
LT_3:
    s_waitcnt vmcnt(28)
    buffer_load_dwordx4 v142, s[64:67], s84 offen offset:0 nt lds
    buffer_load_dwordx4 v143, s[64:67], s84 offen offset:1008 nt lds
    buffer_load_dwordx4 v144, s[64:67], s84 offen offset:2016 nt lds
    s_add_u32 s84, s84, 24192
    s_add_u32 m0, m0, 3024
    s_cmp_lt_u32 m0, 147904
    s_cbranch_scc1 LT_3
    s_mov_b32 m0, 147904
    s_waitcnt vmcnt(30)
    buffer_load_dwordx4 v142, s[64:67], s84 offen offset:0 nt lds
    s_add_u32 s84, s84, 24192
    s_mov_b32 m0, 78848
    s_waitcnt vmcnt(27)
    buffer_load_dwordx4 v130, s[48:51], s82 offen offset:0 nt lds
    buffer_load_dwordx4 v131, s[48:51], s82 offen offset:1024 nt lds
    buffer_load_dwordx4 v132, s[48:51], s82 offen offset:2048 nt lds
    buffer_load_dwordx4 v133, s[48:51], s82 offen offset:3072 nt lds
    s_add_u32 s82, s82, 32768
    s_waitcnt vmcnt(32)
    s_barrier
    s_mov_b32 m0, 82944
LT_6:
    s_waitcnt vmcnt(27)
    buffer_load_dwordx4 v130, s[48:51], s82 offen offset:0 nt lds
    buffer_load_dwordx4 v131, s[48:51], s82 offen offset:1024 nt lds
    buffer_load_dwordx4 v132, s[48:51], s82 offen offset:2048 nt lds
    buffer_load_dwordx4 v133, s[48:51], s82 offen offset:3072 nt lds
    s_add_u32 s82, s82, 32768
    s_add_u32 m0, m0, 4096
    s_cmp_lt_u32 m0, 111616
    s_cbranch_scc1 LT_6
    s_mov_b32 m0, 21248
LT_7:
    s_waitcnt vmcnt(28)
    buffer_load_dwordx4 v139, s[60:63], s80 offen offset:0 nt lds
    buffer_load_dwordx4 v140, s[60:63], s80 offen offset:1008 nt lds
    buffer_load_dwordx4 v141, s[60:63], s80 offen offset:2016 nt lds
    s_add_u32 s80, s80, 193536
    s_add_u32 m0, m0, 3024
    s_cmp_lt_u32 m0, 42416
    s_cbranch_scc1 LT_7
    s_mov_b32 m0, 46080
    s_waitcnt vmcnt(27)
    buffer_load_dwordx4 v146, s[52:55], s75 offen offset:0 nt lds
    buffer_load_dwordx4 v147, s[52:55], s75 offen offset:1024 nt lds
    buffer_load_dwordx4 v148, s[52:55], s75 offen offset:2048 nt lds
    buffer_load_dwordx4 v149, s[52:55], s75 offen offset:3072 nt lds
    s_add_u32 s75, s75, 32768
    s_waitcnt vmcnt(25)
    s_barrier
    s_barrier
    s_mov_b32 m0, 50176
LT_9:
    s_waitcnt vmcnt(27)
    buffer_load_dwordx4 v146, s[52:55], s75 offen offset:0 nt lds
    buffer_load_dwordx4 v147, s[52:55], s75 offen offset:1024 nt lds
    buffer_load_dwordx4 v148, s[52:55], s75 offen offset:2048 nt lds
    buffer_load_dwordx4 v149, s[52:55], s75 offen offset:3072 nt lds
    s_add_u32 s75, s75, 32768
    s_add_u32 m0, m0, 4096
    s_cmp_lt_u32 m0, 78848
    s_cbranch_scc1 LT_9
    s_waitcnt vmcnt(63)
    s_barrier
    s_barrier
    s_waitcnt vmcnt(8)
    s_barrier
    s_waitcnt vmcnt(0)
    s_barrier
    s_barrier
    s_waitcnt vmcnt(0)
    s_endpgm
LD_M:
    s_mov_b32 m0, 120688
LT_10:
    s_waitcnt vmcnt(17)
    buffer_load_dwordx4 v142, s[64:67], s84 offen offset:0 nt lds
    buffer_load_dwordx4 v143, s[64:67], s84 offen offset:1008 nt lds
    buffer_load_dwordx4 v144, s[64:67], s84 offen offset:2016 nt lds
    s_add_u32 s84, s84, 24192
    s_add_u32 m0, m0, 3024
    s_cmp_lt_u32 m0, 132784
    s_cbranch_scc1 LT_10
    s_mov_b32 m0, 78848
LT_11:
    s_waitcnt vmcnt(16)
    buffer_load_dwordx4 v130, s[48:51], s82 offen offset:0 nt lds
    buffer_load_dwordx4 v131, s[48:51], s82 offen offset:1024 nt lds
    buffer_load_dwordx4 v132, s[48:51], s82 offen offset:2048 nt lds
    buffer_load_dwordx4 v133, s[48:51], s82 offen offset:3072 nt lds
    s_add_u32 s82, s82, 32768
    s_add_u32 m0, m0, 4096
    s_cmp_lt_u32 m0, 87040
    s_cbranch_scc1 LT_11
    s_waitcnt vmcnt(20)
    s_barrier
    s_mov_b32 m0, 87040
LT_12:
    s_waitcnt vmcnt(16)
    buffer_load_dwordx4 v130, s[48:51], s82 offen offset:0 nt lds
    buffer_load_dwordx4 v131, s[48:51], s82 offen offset:1024 nt lds
    buffer_load_dwordx4 v132, s[48:51], s82 offen offset:2048 nt lds
    buffer_load_dwordx4 v133, s[48:51], s82 offen offset:3072 nt lds
    s_add_u32 s82, s82, 32768
    s_add_u32 m0, m0, 4096
    s_cmp_lt_u32 m0, 111616
    s_cbranch_scc1 LT_12
    s_mov_b32 m0, 46080
LT_13:
    s_waitcnt vmcnt(16)
    buffer_load_dwordx4 v146, s[52:55], s75 offen offset:0 nt lds
    buffer_load_dwordx4 v147, s[52:55], s75 offen offset:1024 nt lds
    buffer_load_dwordx4 v148, s[52:55], s75 offen offset:2048 nt lds
    buffer_load_dwordx4 v149, s[52:55], s75 offen offset:3072 nt lds
    s_add_u32 s75, s75, 32768
    s_add_u32 m0, m0, 4096
    s_cmp_lt_u32 m0, 70656
    s_cbranch_scc1 LT_13
    s_waitcnt vmcnt(24)
    s_barrier
    s_barrier
    s_mov_b32 m0, 70656
LT_14:
    s_waitcnt vmcnt(16)
    buffer_load_dwordx4 v146, s[52:55], s75 offen offset:0 nt lds
    buffer_load_dwordx4 v147, s[52:55], s75 offen offset:1024 nt lds
    buffer_load_dwordx4 v148, s[52:55], s75 offen offset:2048 nt lds
    buffer_load_dwordx4 v149, s[52:55], s75 offen offset:3072 nt lds
    s_add_u32 s75, s75, 32768
    s_add_u32 m0, m0, 4096
    s_cmp_lt_u32 m0, 78848
    s_cbranch_scc1 LT_14
    s_mov_b32 m0, 132784
LT_15:
    s_waitcnt vmcnt(17)
    buffer_load_dwordx4 v142, s[64:67], s84 offen offset:0 nt lds
    buffer_load_dwordx4 v143, s[64:67], s84 offen offset:1008 nt lds
    buffer_load_dwordx4 v144, s[64:67], s84 offen offset:2016 nt lds
    s_add_u32 s84, s84, 24192
    s_add_u32 m0, m0, 3024
    s_cmp_lt_u32 m0, 144880
    s_cbranch_scc1 LT_15
    s_barrier
    s_mov_b32 m0, 144880
    s_waitcnt vmcnt(17)
    buffer_load_dwordx4 v142, s[64:67], s84 offen offset:0 nt lds
    buffer_load_dwordx4 v143, s[64:67], s84 offen offset:1008 nt lds
    buffer_load_dwordx4 v144, s[64:67], s84 offen offset:2016 nt lds
    s_add_u32 s84, s84, 24192
    s_barrier
    s_mov_b32 m0, 147904
    s_waitcnt vmcnt(17)
    buffer_load_dwordx4 v142, s[64:67], s84 offen offset:0 nt lds
    buffer_load_dwordx4 v143, s[64:67], s84 offen offset:1008 nt lds
    buffer_load_dwordx4 v144, s[64:67], s84 offen offset:2016 nt lds
    s_add_u32 s84, s84, 24192
    s_waitcnt vmcnt(26)
    s_barrier
    s_waitcnt vmcnt(18)
    s_barrier
    s_mov_b32 m0, 150928
    s_waitcnt vmcnt(17)
    buffer_load_dwordx4 v142, s[64:67], s84 offen offset:0 nt lds
    buffer_load_dwordx4 v143, s[64:67], s84 offen offset:1008 nt lds
    buffer_load_dwordx4 v144, s[64:67], s84 offen offset:2016 nt lds
    s_add_u32 s84, s84, 24192
    s_barrier
    s_mov_b32 m0, 21248
LT_19:
    s_waitcnt vmcnt(31)
    buffer_load_dwordx4 v139, s[60:63], s80 offen offset:0 nt lds
    buffer_load_dwordx4 v140, s[60:63], s80 offen offset:1008 nt lds
    buffer_load_dwordx4 v141, s[60:63], s80 offen offset:2016 nt lds
    s_add_u32 s80, s80, 193536
    s_add_u32 m0, m0, 3024
    s_cmp_lt_u32 m0, 42416
    s_cbranch_scc1 LT_19
    s_waitcnt vmcnt(0)
    s_endpgm
W_START:
    s_sub_u32 s74, s74, 2
    s_min_u32 s74, s74, 8
    s_and_b32 s75, s74, 3
    s_mov_b32 s84, 0x20000
    s_lshl_b32 s81, s76, 17
    s_add_u32 s82, s81, 63488
    v_lshlrev_b32 v40, 4, v1
    s_lshr_b32 s85, s2, 4
    s_lshl_b32 s85, s85, 14
    s_and_b32 s86, s2, 15
    s_lshl_b32 s86, s86, 7
    s_add_u32 s85, s85, s86
    s_add_u32 s83, s85, 1054720
    s_waitcnt lgkmcnt(0)
    s_cmp_lg_u32 s74, 0
    s_cbranch_scc1 P_NOTLB
    s_lshl_b32 s86, s76, 1
    s_add_u32 s87, s86, s89
    s_lshl_b32 s85, s89, 4
    s_add_u32 s85, s85, s86
    s_lshr_b32 s86, s77, 4
    s_add_u32 s85, s85, s86
    s_lshl_b32 s85, s85, 20
    s_add_u32 s85, s85, 786432
    s_lshl_b32 s87, s87, 1
    s_add_u32 s87, s87, s86
    s_cmp_lg_u32 s79, 0
    s_cbranch_scc1 P_T0
    s_load_dword s16, s[26:27], s85
    s_branch P_NOTLB
P_T0:
    s_cmp_lg_u32 s79, 1
    s_cbranch_scc1 P_T1
    s_load_dword s16, s[28:29], s85
    s_branch P_NOTLB
P_T1:
    s_cmp_lg_u32 s79, 2
    s_cbranch_scc1 P_T2
    s_mul_i32 s85, s87, 147456
    s_load_dword s16, s[32:33], s85
    s_branch P_NOTLB
P_T2:
    s_cmp_lg_u32 s79, 3
    s_cbranch_scc1 P_T3
    s_mul_i32 s85, s87, 165888
    s_load_dword s16, s[40:41], s85
    s_branch P_NOTLB
P_T3:
    s_cmp_lg_u32 s79, 4
    s_cbranch_scc1 P_T4
    s_mul_i32 s85, s78, 1327104
    s_load_dword s16, s[36:37], s85
    s_add_u32 s85, s85, 1317888
    s_load_dword s16, s[36:37], s85
    s_branch P_NOTLB
P_T4:
    s_cmp_lg_u32 s79, 5
    s_cbranch_scc1 P_T5
    s_load_dword s16, s[24:25], 0
    s_load_dword s16, s[38:39], 0
    s_branch P_NOTLB
P_T5:
    s_cmp_lg_u32 s79, 6
    s_cbranch_scc1 P_T6
    s_load_dword s16, s[42:43], 0
    s_load_dword s16, s[44:45], 0
    s_branch P_NOTLB
P_T6:
    s_load_dword s16, s[46:47], 192
P_NOTLB:
    s_mov_b32 s4, s72
    s_and_b32 s5, s73, 0xffff
    s_mov_b32 s6, 268435456
    s_mov_b32 s7, 0x20000
    s_cmp_lg_u32 s74, 8
    s_cbranch_scc1 P_NOCLR
    v_mov_b32 v36, -1
    v_mov_b32 v37, -1
    v_mov_b32 v38, -1
    v_mov_b32 v39, -1
    s_mul_i32 s86, s76, 768
    s_lshl_b32 s87, s77, 13
    s_add_u32 s86, s86, s87
    s_add_u32 s86, s86, 1048576
    v_add_u32 v41, s86, v40
    v_and_b32 v42, 8, v1
    v_lshlrev_b32 v42, 10, v42
    v_and_b32 v43, 0x70, v40
    v_add3_u32 v42, v42, v43, s83
    v_cmp_lt_u32 vcc, 47, v1
    s_nop 1
    v_cndmask_b32 v41, v41, v42, vcc
    buffer_store_dwordx4 v[36:39], v41, s[4:7], 0 offen sc1
    s_mul_i32 s85, s77, 1536
    s_add_u32 s85, s85, s81
    s_add_u32 s85, s85, 24832
    buffer_store_dwordx4 v[36:39], v40, s[4:7], s85 offen offset:0
    s_mov_b32 exec_hi, 0
    buffer_store_dwordx4 v[36:39], v40, s[4:7], s85 offen offset:1024
    s_mov_b64 exec, -1
    v_lshlrev_b32 v41, 2, v1
    v_mov_b32 v42, 0xff800000
    v_mov_b32 v43, 0x3f803f80
    ds_write_b32 v41, v43 offset:43136
    ds_write_b32 v41, v43 offset:43200
    s_mov_b64 exec, 0xffff
    ds_write_b32 v41, v42 offset:44800
    ds_write_b32 v41, v36 offset:44864
    s_mov_b64 exec, -1
    v_lshrrev_b32 v41, 1, v1
    v_lshlrev_b32 v41, 13, v41
    v_and_b32 v42, 1, v1
    v_lshl_add_u32 v41, v42, 7, v41
    s_lshl_b32 s86, s79, 10
    s_lshl_b32 s87, s78, 8
    s_add_u32 s86, s86, s87
    v_add_u32 v42, s86, v41
    v_cmp_gt_u32 vcc, 6, v1
    s_nop 1
    v_cndmask_b32 v41, v41, v42, vcc
    s_mov_b32 s86, 130816
    v_writelane_b32 v41, s86, 8
    s_mov_b64 exec, 0x1ff
    buffer_load_dword v44, v41, s[4:7], s81 offen sc1
    s_mov_b64 exec, -1
P_NOCLR:
    s_mov_b32 s12, s46
    s_and_b32 s13, s47, 0xffff
    s_mov_b32 s14, 256
    s_mov_b32 s15, 0x20000
    s_mov_b32 s8, s44
    s_and_b32 s9, s45, 0xffff
    s_mov_b32 s10, 2304
    s_mov_b32 s11, 0x20000
    s_mov_b32 s33, s83
    s_load_dword s32, s[72:73], 130944
    v_and_b32 v4, 1, v3
    v_lshrrev_b32 v5, 1, v3
    v_lshl_add_u32 v4, v4, 1, v5
    v_and_b32 v5, 6, v1
    v_lshl_add_u32 v4, v4, 3, v5
    s_lshl_b32 s85, s74, 5
    v_add_u32 v4, s85, v4
    v_add_u32 v33, 154112, v4
    v_and_b32 v7, 1, v1
    v_mul_u32_u24 v9, 320, v7
    v_add_u32 v9, v9, v4
    v_lshlrev_b32 v4, 4, v7
    v_mov_b32 v6, 0x3f80
    v_lshlrev_b32 v4, v4, v6
    v_cmp_eq_u32 vcc, 0, v5
    s_nop 1
    v_cndmask_b32 v164, 0, v4, vcc
    v_cmp_eq_u32 vcc, 2, v5
    s_nop 1
    v_cndmask_b32 v165, 0, v4, vcc
    v_cmp_eq_u32 vcc, 4, v5
    s_nop 1
    v_cndmask_b32 v166, 0, v4, vcc
    v_cmp_eq_u32 vcc, 6, v5
    s_nop 1
    v_cndmask_b32 v167, 0, v4, vcc
    v_and_b32 v4, 3, v2
    s_lshl_b32 s85, s74, 6
    v_lshl_add_u32 v4, v4, 4, s85
    v_cmp_lt_u32 vcc, 287, v4
    v_add_u32 v5, 16128, v4
    s_nop 0
    v_cndmask_b32 v4, v4, v5, vcc
    v_and_b32 v5, 12, v2
    v_add_u32 v5, v5, v3
    v_mul_u32_u24 v5, 384, v5
    s_lshl_b32 s85, s78, 15
    v_add3_u32 v8, v4, v5, s85
    v_min_u32 v6, 2, v2
    v_mul_u32_u24 v6, 320, v6
    v_lshl_add_u32 v10, v3, 4, v6
    v_lshl_add_u32 v11, v3, 3, v6
    v_mul_u32_u24 v21, 320, v7
    v_lshl_add_u32 v18, v3, 4, v21
    v_lshrrev_b32 v6, 2, v2
    v_and_b32 v5, 3, v2
    v_lshl_add_u32 v4, v3, 3, v6
    v_mul_u32_u24 v125, 144, v4
    v_lshl_add_u32 v125, v5, 3, v125
    s_and_b32 s88, s77, 15
    s_lshl_b32 s80, s88, 6
    s_add_u32 s80, s80, s81
    s_add_u32 s80, s80, 25600
    s_mov_b32 s94, 0x00070007
    s_mov_b32 s95, 0x00070007
    s_mov_b32 s96, 0x00030003
    s_mov_b32 s97, 0x00030003
    s_mov_b32 s100, 0x55555555
    s_mov_b32 s101, 0x55555555
    v_mov_b32 v35, 0x3727c5ac
    v_mov_b32 v144, 0
    v_mov_b32 v145, 0
    s_cmp_lt_u32 s77, 16
    s_cbranch_scc0 R_M
R_O:
    s_cmp_eq_u32 s74, 8
    s_cbranch_scc1 S_Oax
    s_cmp_ge_u32 s74, 4
    s_cbranch_scc1 S_Og2
S_Og1:
    s_lshl_b32 s86, s75, 5
    v_add_u32 v105, s86, v125
    v_lshl_add_u32 v89, v3, 2, v6
    v_mul_u32_u24 v89, 144, v89
    v_lshl_add_u32 v89, v5, 3, v89
    v_add_u32 v89, s86, v89
    v_mov_b32 v86, 0
    v_mov_b32 v87, 0
    s_lshl_b32 s86, s75, 6
    v_lshl_add_u32 v146, v3, 4, s86
    v_cmp_eq_u32 vcc, 2, v2
    v_mul_u32_u24 v147, 9216, v2
    v_add_u32 v147, 27648, v147
    v_mov_b32 v148, 62464
    v_cndmask_b32 v147, v147, v148, vcc
    s_mul_i32 s86, s79, 288
    s_mul_i32 s87, s78, 2304
    s_add_u32 s86, s86, s87
    v_add3_u32 v13, v146, v147, s86
    v_lshlrev_b32 v147, 13, v2
    v_add_u32 v147, 8192, v147
    v_cndmask_b32 v147, v147, 0, vcc
    s_lshl_b32 s86, s79, 10
    s_lshl_b32 s87, s78, 8
    s_add_u32 s86, s86, s87
    v_add3_u32 v12, v146, v147, s86
    s_lshl_b32 s86, s75, 10
    v_lshl_add_u32 v15, v1, 2, s86
    s_lshl_b32 s87, s89, 13
    s_add_u32 s87, s87, 8192
    v_add_u32 v14, s87, v15
    s_lshl_b32 s86, s78, 6
    s_add_u32 s86, s86, 24576
    v_lshl_add_u32 v16, v5, 4, s86
    s_lshr_b32 s86, s75, 1
    s_mul_i32 s86, s86, 320
    s_and_b32 s87, s75, 1
    s_lshl_b32 s87, s87, 7
    s_add_u32 s86, s86, s87
    v_lshl_add_u32 v17, v1, 1, s86
    v_lshlrev_b32 v20, 4, v7
    v_lshl_add_u32 v19, v3, 2, v20
    s_lshl_b32 s86, s75, 6
    v_lshl_add_u32 v21, v3, 3, v21
    v_add_u32 v21, s86, v21
    v_and_b32 v146, 6, v2
    v_add_u32 v21, v21, v146
    v_lshrrev_b32 v146, 3, v2
    v_lshl_add_u32 v21, v146, 5, v21
    s_mov_b32 s34, 0xcccccccc
    s_mov_b32 s35, 0xcccccccc
    s_mov_b32 s36, 0xf0f0f0f0
    s_mov_b32 s37, 0xf0f0f0f0
    s_mov_b32 s38, 0xff00ff00
    s_mov_b32 s39, 0xff00ff00
    v_lshrrev_b32 v146, 1, v1
    s_lshl_b32 s86, s75, 5
    v_add_u32 v146, s86, v146
    s_lshl_b32 s86, s76, 1
    s_add_u32 s86, s86, s89
    s_mul_i32 s86, s86, 384
    s_lshl_b32 s87, s79, 14
    s_add_u32 s86, s86, s87
    v_lshl_add_u32 v25, v146, 2, s86
    s_and_b32 s86, s79, 1
    s_lshl_b32 s86, s86, 3
    v_subrev_u32 v146, s86, v146
    v_min_u32 v146, 71, v146
    v_mul_u32_u24 v146, 48, v146
    v_lshl_add_u32 v23, v7, 4, v146
    v_lshl_add_u32 v24, v7, 2, v146
    v_add_u32 v24, 32, v24
    s_cmp_lt_u32 s75, 3
    s_cselect_b64 s[98:99], s[100:101], 0
    s_cmp_eq_u32 s75, 2
    s_cselect_b64 s[100:101], 1, 0
    s_waitcnt lgkmcnt(0)
    s_add_u32 s32, s32, 1
    v_mov_b32 v7, 0xff
    s_barrier
    ds_read_b128 v[126:129], v10 offset:42496
    ds_read_b128 v[130:133], v10 offset:42560
    ds_read_b128 v[134:137], v10 offset:42624
    ds_read_b128 v[138:141], v10 offset:42688
    ds_read_b64 v[142:143], v11 offset:42752
    ds_read_b64_tr_b16 v[84:85], v89 offset:18432
    ds_read_b64_tr_b16 v[68:69], v105 offset:0
    ds_read_b64_tr_b16 v[70:71], v105 offset:576
    ds_read_b64_tr_b16 v[72:73], v105 offset:4608
    ds_read_b64_tr_b16 v[74:75], v105 offset:5184
    ds_read_b64_tr_b16 v[76:77], v105 offset:9216
    ds_read_b64_tr_b16 v[78:79], v105 offset:9792
    ds_read_b64_tr_b16 v[80:81], v105 offset:13824
    ds_read_b64_tr_b16 v[82:83], v105 offset:14400
    ds_read_u16 v32, v9 offset:42496
    ds_read_u16 v33, v33
    s_waitcnt lgkmcnt(0)
    v_mfma_f32_16x16x32_bf16 v[146:149], v[68:71], v[126:129], 0
    v_mfma_f32_16x16x32_bf16 v[146:149], v[72:75], v[130:133], v[146:149]
    v_mfma_f32_16x16x32_bf16 v[146:149], v[76:79], v[134:137], v[146:149]
    v_mfma_f32_16x16x32_bf16 v[146:149], v[80:83], v[138:141], v[146:149]
    v_mfma_f32_16x16x32_bf16 v[146:149], v[84:87], v[142:145], v[146:149]
    v_lshlrev_b32 v32, 16, v32
    v_lshlrev_b32 v33, 16, v33
    s_mov_b64 exec, s[94:95]
    s_nop 4
    v_bfi_b32 v130, v7, s32, v146
    v_bfi_b32 v131, v7, s32, v147
    v_bfi_b32 v132, v7, s32, v148
    v_bfi_b32 v133, v7, s32, v149
    buffer_store_dwordx4 v[130:133], v12, s[4:7], s81 offen
    s_mov_b64 exec, -1
    s_mov_b64 exec, 0
    s_branch T_Og1
U_Og1:
    s_mov_b64 exec, -1
    s_barrier
    buffer_load_dword v154, v14, s[4:7], s81 offen offset:0 sc1
    buffer_load_dword v155, v14, s[4:7], s81 offen offset:256 sc1
    buffer_load_dword v156, v14, s[4:7], s81 offen offset:512 sc1
    buffer_load_dword v157, v14, s[4:7], s81 offen offset:768 sc1
    buffer_load_dwordx4 v[158:161], v16, s[4:7], s81 offen sc1
    buffer_load_dword v126, v15, s[4:7], s81 offen offset:0 sc1
    buffer_load_dword v127, v15, s[4:7], s81 offen offset:256 sc1
    buffer_load_dword v128, v15, s[4:7], s81 offen offset:512 sc1
    buffer_load_dword v129, v15, s[4:7], s81 offen offset:768 sc1
    s_barrier
    v_xor_b32 v6, v2, v3
    v_lshlrev_b32 v6, 4, v6
    v_lshl_add_u32 v6, v2, 8, v6
    s_lshl_b32 s85, s75, 13
    s_add_u32 s85, s85, 78848
    v_add_u32 v6, s85, v6
    ds_read_b128 v[36:39], v6 offset:0
    ds_read_b128 v[52:55], v6 offset:4096
    v_xor_b32 v7, 64, v6
    ds_read_b128 v[40:43], v7 offset:0
    ds_read_b128 v[56:59], v7 offset:4096
    v_xor_b32 v7, 128, v6
    ds_read_b128 v[44:47], v7 offset:0
    ds_read_b128 v[60:63], v7 offset:4096
    v_xor_b32 v7, 192, v6
    ds_read_b128 v[48:51], v7 offset:0
    ds_read_b128 v[64:67], v7 offset:4096
    s_branch QW1
QR2:
    v_mov_b32 v7, 44864
VW3:
    ds_read_b32 v6, v7
    s_sub_u32 s84, s84, 1
    s_cbranch_scc1 L_END
    s_waitcnt lgkmcnt(0)
    v_cmp_eq_u32 vcc, -1, v6
    s_cbranch_vccnz VW3
    v_cmp_eq_u32 s[90:91], 0, v6
    v_cmp_ne_u32 s[92:93], 0, v6
    s_and_b64 exec, s[94:95], s[92:93]
    s_cbranch_execz QF4
    buffer_store_dwordx4 v[130:133], v12, s[4:7], s81 offen sc1
QF4:
    s_mov_b64 exec, -1
    s_sub_u32 s84, s84, 1
    s_cbranch_scc1 L_END
    buffer_load_dword v154, v14, s[4:7], s81 offen offset:0 sc1
    buffer_load_dword v155, v14, s[4:7], s81 offen offset:256 sc1
    buffer_load_dword v156, v14, s[4:7], s81 offen offset:512 sc1
    buffer_load_dword v157, v14, s[4:7], s81 offen offset:768 sc1
    buffer_load_dwordx4 v[158:161], v16, s[4:7], s81 offen sc1
    buffer_load_dword v126, v15, s[4:7], s81 offen offset:0 sc1
    buffer_load_dword v127, v15, s[4:7], s81 offen offset:256 sc1
    buffer_load_dword v128, v15, s[4:7], s81 offen offset:512 sc1
    buffer_load_dword v129, v15, s[4:7], s81 offen offset:768 sc1
QW1:
    s_waitcnt vmcnt(0)
    v_bitop3_b32 v4, v154, v155, s32 bitop3:0x7e
    v_bitop3_b32 v5, v156, v157, s32 bitop3:0x7e
    v_bitop3_b32 v6, v126, v127, s32 bitop3:0x7e
    v_bitop3_b32 v7, v128, v129, s32 bitop3:0x7e
    v_or3_b32 v4, v4, v5, v6
    v_or_b32 v4, v4, v7
    v_bitop3_b32 v5, v160, v161, s32 bitop3:0x7e
    v_and_b32 v4, 0xff, v4
    v_or_b32 v4, v4, v5
    v_cmp_ne_u32 vcc, 0, v4
    s_cbranch_vccnz QR2
    v_and_b32 v154, 0xffffff00, v154
    v_and_b32 v155, 0xffffff00, v155
    v_and_b32 v156, 0xffffff00, v156
    v_and_b32 v157, 0xffffff00, v157
    v_and_b32 v126, 0xffffff00, v126
    v_and_b32 v127, 0xffffff00, v127
    v_and_b32 v128, 0xffffff00, v128
    v_and_b32 v129, 0xffffff00, v129
    v_add_f32 v4, v126, v127
    v_add_f32 v5, v128, v129
    v_add_f32 v15, v4, v5
    v_add_f32_dpp v150, v158, v158 quad_perm:[1,0,3,2] row_mask:0xf bank_mask:0xf
    v_add_f32_dpp v151, v159, v159 quad_perm:[1,0,3,2] row_mask:0xf bank_mask:0xf
    v_add_f32 v146, v154, v155
    v_add_f32_dpp v150, v150, v150 quad_perm:[2,3,0,1] row_mask:0xf bank_mask:0xf
    v_add_f32_dpp v151, v151, v151 quad_perm:[2,3,0,1] row_mask:0xf bank_mask:0xf
    v_mul_f32 v4, 0x3ae38e39, v150
    v_fmamk_f32 v151, v151, 0x3ae38e39, v35
    v_fma_f32 v151, -v4, v4, v151
    v_max_f32 v151, v151, v35
    v_rsq_f32 v5, v151
    v_add_f32 v148, v156, v157
    v_add_f32 v146, v146, v148
    v_fma_f32 v146, -v4, v15, v146
    v_mul_f32 v5, 0x3e0293ee, v5
    v_mul_f32 v146, v146, v5
    v_cvt_pk_bf16_f32 v146, v146, v146
    ds_write_b16 v17, v146 offset:43520
    v_mov_b32 v7, 44864
VW5:
    ds_read_b32 v6, v7
    s_sub_u32 s84, s84, 1
    s_cbranch_scc1 L_END
    s_waitcnt lgkmcnt(0)
    v_cmp_eq_u32 vcc, -1, v6
    s_cbranch_vccnz VW5
    v_cmp_eq_u32 s[90:91], 0, v6
    v_cmp_ne_u32 s[92:93], 0, v6
    s_and_b64 exec, s[94:95], s[92:93]
    s_cbranch_execz QF6
    buffer_store_dwordx4 v[130:133], v12, s[4:7], s81 offen sc1
QF6:
    s_mov_b64 exec, -1
    s_branch B_Og1
S_Og2:
    v_and_b32 v146, 1, v3
    v_lshl_or_b32 v146, v146, 2, v6
    v_lshlrev_b32 v146, 5, v146
    s_lshl_b32 s86, s75, 6
    v_lshl_add_u32 v147, v5, 4, s86
    v_xor_b32 v146, v146, v147
    v_lshl_add_u32 v67, v4, 8, v146
    v_add_u32 v67, 46080, v67
    s_lshl_b32 s86, s75, 10
    s_lshl_b32 s87, s88, 4
    s_add_u32 s86, s86, s87
    s_add_u32 s86, s86, 46080
    v_lshlrev_b32 v146, 12, v7
    v_lshl_add_u32 v146, v3, 8, v146
    v_add_u32 v12, s86, v146
    s_lshr_b32 s86, s79, 2
    s_lshl_b32 s86, s86, 7
    s_lshl_b32 s87, s78, 4
    s_add_u32 s86, s86, s87
    s_add_u32 s86, s86, 24576
    v_lshl_add_u32 v14, v7, 6, s86
    s_and_b32 s79, s79, 3
    s_xor_b32 s86, s75, 1
    s_or_b32 s79, s79, s86
    s_lshl_b32 s86, s89, 13
    s_lshl_b32 s87, s75, 11
    s_add_u32 s86, s86, s87
    s_add_u32 s86, s86, 46080
    v_lshlrev_b32 v146, 4, v2
    v_lshl_add_u32 v146, v3, 8, v146
    v_add_u32 v26, s86, v146
    s_lshl_b32 s86, s89, 8
    s_lshr_b32 s87, s75, 1
    s_lshl_b32 s87, s87, 7
    s_add_u32 s86, s86, s87
    s_add_u32 s86, s86, 25088
    v_lshlrev_b32 v146, 3, v5
    v_lshl_add_u32 v146, v3, 5, v146
    v_add_u32 v27, s86, v146
    s_mul_i32 s87, s75, 9216
    s_add_u32 s87, s87, 111616
    v_add_u32 v125, s87, v125
    v_lshrrev_b32 v146, 1, v3
    v_mul_u32_u24 v146, 3840, v146
    v_and_b32 v147, 1, v3
    v_lshl_add_u32 v146, v147, 2, v146
    v_mul_u32_u24 v22, 48, v2
    s_lshl_b32 s86, s75, 3
    v_add3_u32 v22, v22, v146, s86
    s_waitcnt lgkmcnt(0)
    s_add_u32 s32, s32, 1
    v_mov_b32 v150, s32
    v_mov_b32 v151, s32
    s_barrier
    s_cmp_lg_u32 s79, 0
    s_cbranch_scc1 GS20
    ds_read_b128 v[126:129], v10 offset:42496
    ds_read_b128 v[130:133], v10 offset:42560
    ds_read_b128 v[134:137], v10 offset:42624
    ds_read_b128 v[138:141], v10 offset:42688
    ds_read_b64 v[142:143], v11 offset:42752
    v_cmp_eq_u32 vcc, 1, v1
    s_waitcnt lgkmcnt(4)
    v_mfma_f32_16x16x32_bf16 v[146:149], v[126:129], v[126:129], 0
    s_waitcnt lgkmcnt(3)
    v_mfma_f32_16x16x32_bf16 v[146:149], v[130:133], v[130:133], v[146:149]
    s_waitcnt lgkmcnt(2)
    v_mfma_f32_16x16x32_bf16 v[146:149], v[134:137], v[134:137], v[146:149]
    s_waitcnt lgkmcnt(1)
    v_mfma_f32_16x16x32_bf16 v[146:149], v[138:141], v[138:141], v[146:149]
    s_waitcnt lgkmcnt(0)
    v_mfma_f32_16x16x32_bf16 v[146:149], v[142:145], v[142:145], v[146:149]
    s_nop 7
    v_cndmask_b32 v149, v146, v147, vcc
    s_mov_b64 exec, 3
    buffer_store_dwordx4 v[148:151], v14, s[4:7], s81 offen
    s_mov_b64 exec, -1
GS20:
    ds_read_u16 v32, v9 offset:42496
    ds_read_u16 v33, v33
    s_mov_b64 exec, 0
    s_branch T_Og2
U_Og2:
    s_mov_b64 exec, -1
    s_andn2_b32 s86, s33, 8192
    s_or_b32 s87, s33, 8192
    v_mov_b32 v4, 0
    s_memtime s[24:25]
    s_load_dword s30, s[72:73], s86 glc
    s_waitcnt lgkmcnt(0)
    s_memtime s[26:27]
    s_load_dword s30, s[72:73], s87 glc
    s_waitcnt lgkmcnt(0)
    s_memtime s[28:29]
    s_sub_u32 s86, s26, s24
    v_mov_b32 v5, s86
    s_waitcnt lgkmcnt(0)
    s_sub_u32 s87, s28, s26
    v_mov_b32 v6, s87
    s_mov_b64 exec, 1
    ds_min_u32 v4, v5 offset:44872
    ds_min_u32 v4, v6 offset:44876
    s_mov_b64 exec, -1
    s_barrier
    s_barrier
    v_mov_b32 v7, 44864
VW21:
    ds_read_b32 v6, v7
    s_sub_u32 s84, s84, 1
    s_cbranch_scc1 L_END
    s_waitcnt lgkmcnt(0)
    v_cmp_eq_u32 vcc, -1, v6
    s_cbranch_vccnz VW21
    v_cmp_eq_u32 s[90:91], 0, v6
    v_cmp_ne_u32 s[92:93], 0, v6
    v_lshlrev_b32 v32, 16, v32
    v_lshlrev_b32 v33, 16, v33
    s_cmp_lg_u32 s79, 0
    s_cbranch_scc1 QF22
    s_and_b64 exec, 3, s[92:93]
    s_cbranch_execz QF22
    buffer_store_dwordx4 v[148:151], v14, s[4:7], s81 offen sc1
QF22:
    s_mov_b64 exec, -1
    s_branch B_Og2
S_Oax:
    s_lshl_b32 s86, 4, 5
    v_add_u32 v105, s86, v125
    v_lshl_add_u32 v89, v3, 2, v6
    v_mul_u32_u24 v89, 144, v89
    v_lshl_add_u32 v89, v5, 3, v89
    v_add_u32 v89, s86, v89
    v_mov_b32 v86, 0
    v_mov_b32 v87, 0
    s_lshl_b32 s86, 4, 6
    v_lshl_add_u32 v146, v3, 4, s86
    v_cmp_eq_u32 vcc, 2, v2
    v_mul_u32_u24 v147, 9216, v2
    v_add_u32 v147, 27648, v147
    v_mov_b32 v148, 62464
    v_cndmask_b32 v147, v147, v148, vcc
    s_mul_i32 s86, s79, 288
    s_mul_i32 s87, s78, 2304
    s_add_u32 s86, s86, s87
    v_add3_u32 v13, v146, v147, s86
    s_mov_b32 s95, 0
    s_mov_b32 s97, 0
    v_lshrrev_b32 v151, 5, v1
    v_and_b32 v150, 31, v1
    v_mul_u32_u24 v14, 320, v151
    v_lshl_add_u32 v14, v150, 3, v14
    v_lshlrev_b32 v20, 4, v151
    s_lshl_b32 s86, s88, 3
    s_add_u32 s86, s86, 25088
    v_lshl_add_u32 v12, v151, 7, s86
    s_mov_b32 s98, 1
    s_mov_b32 s99, 1
    s_waitcnt lgkmcnt(0)
    s_add_u32 s32, s32, 1
    s_getreg_b32 s87, hwreg(HW_REG_XCC_ID, 0, 4)
    s_mul_i32 s30, s32, 0x9e3779b1
    s_andn2_b32 s30, s30, 15
    s_or_b32 s30, s30, s87
    v_mov_b32 v45, s30
    s_add_u32 s31, s81, 130816
    s_lshl_b32 s86, s77, 2
    s_add_u32 s28, s31, s86
    v_and_b32 v42, 31, v1
    v_lshlrev_b32 v42, 2, v42
    s_mov_b64 exec, 1
    s_waitcnt vmcnt(0)
    buffer_store_dword v45, off, s[4:7], s28
    s_mov_b64 exec, -1
    s_barrier
    ds_read_u16 v32, v9 offset:42496
    ds_read_u16 v33, v33
    s_mov_b32 s29, 3
    s_mov_b64 exec, 0
    s_branch T_Oax
U_Oax:
    s_mov_b64 exec, -1
    s_barrier
    buffer_load_dword v43, v42, s[4:7], s31 offen sc1
    s_barrier
    s_waitcnt lgkmcnt(0)
    v_lshlrev_b32 v32, 16, v32
    v_lshlrev_b32 v33, 16, v33
FL41:
    s_mov_b32 s86, 0
    s_waitcnt vmcnt(0)
    v_xor_b32 v4, v45, v43
    v_cmp_ne_u32 vcc, 0, v4
    s_cbranch_vccz FL42
    v_cmp_lt_u32 s[92:93], 15, v4
    s_sub_u32 s29, s29, 1
    s_max_i32 s29, s29, 0
    s_cmp_eq_u64 vcc, s[92:93]
    s_cselect_b32 s87, s29, 0
    s_cmp_lg_u32 s87, 0
    s_cbranch_scc1 FL45
    s_mov_b64 exec, 1
    buffer_store_dword v45, off, s[4:7], s28 sc1
    s_mov_b64 exec, -1
    s_mov_b32 s86, 1
    s_cmp_eq_u64 s[92:93], 0
    s_cbranch_scc1 FL42
FL45:
    s_sub_u32 s84, s84, 1
    s_cbranch_scc1 L_END
    buffer_load_dword v43, v42, s[4:7], s31 offen sc1
    s_branch FL41
FL42:
    s_lshl_b32 s28, s76, 2
    v_mov_b32 v4, s86
    v_mov_b32 v5, 44864
    ds_write_b32 v5, v4
    v_cmp_eq_u32 s[90:91], 0, v4
    v_cmp_ne_u32 s[92:93], 0, v4
    s_cmp_eq_u32 s86, 0
    s_cbranch_scc1 FL44
    s_mul_i32 s85, s77, 1536
    s_add_u32 s85, s85, s81
    s_add_u32 s85, s85, 24832
    buffer_store_dwordx4 v[36:39], v40, s[4:7], s85 offen offset:0 sc1
    s_mov_b32 exec_hi, 0
    buffer_store_dwordx4 v[36:39], v40, s[4:7], s85 offen offset:1024 sc1
    s_mov_b64 exec, -1
    s_mov_b32 s29, 1
    s_waitcnt vmcnt(0)
    s_atomic_add s29, s[46:47], s28
FL43:
    s_load_dword s86, s[46:47], s28 glc
    s_sub_u32 s84, s84, 1
    s_cbranch_scc1 L_END
    s_waitcnt lgkmcnt(0)
    s_cmp_lt_u32 s86, 32
    s_cbranch_scc1 FL43
FL44:
    s_cmp_lg_u32 s77, 16
    s_cbranch_scc1 FL46
    s_mov_b32 s31, -1
    s_add_u32 s30, s28, 128
    s_atomic_or s31, s[46:47], s30
FL46:
    s_lshl_b32 s85, s77, 9
    s_add_u32 s85, s85, 46080
    s_min_u32 s86, s77, 19
    s_lshl_b32 s86, s86, 7
    s_add_u32 s86, s86, 25088
    v_lshl_add_u32 v4, v1, 7, s85
    v_writelane_b32 v4, s86, 4
    s_mov_b64 exec, 31
    buffer_load_dword v41, v4, s[4:7], s81 offen sc1
    s_mov_b64 exec, -1
    s_branch B_Oax
R_M:
    s_cmp_eq_u32 s74, 8
    s_cbranch_scc1 S_Max
    s_cmp_ge_u32 s74, 4
    s_cbranch_scc1 S_Mg2
S_Mg1:
    s_lshl_b32 s86, s75, 5
    v_add_u32 v105, s86, v125
    v_lshl_add_u32 v89, v3, 2, v6
    v_mul_u32_u24 v89, 144, v89
    v_lshl_add_u32 v89, v5, 3, v89
    v_add_u32 v89, s86, v89
    v_mov_b32 v86, 0
    v_mov_b32 v87, 0
    s_lshl_b32 s86, s75, 6
    v_lshl_add_u32 v146, v3, 4, s86
    v_cmp_eq_u32 vcc, 2, v2
    v_mul_u32_u24 v147, 9216, v2
    v_add_u32 v147, 27648, v147
    v_mov_b32 v148, 62464
    v_cndmask_b32 v147, v147, v148, vcc
    s_mul_i32 s86, s79, 288
    s_mul_i32 s87, s78, 2304
    s_add_u32 s86, s86, s87
    v_add3_u32 v13, v146, v147, s86
    v_lshlrev_b32 v147, 13, v2
    v_add_u32 v147, 8192, v147
    v_cndmask_b32 v147, v147, 0, vcc
    s_lshl_b32 s86, s79, 10
    s_lshl_b32 s87, s78, 8
    s_add_u32 s86, s86, s87
    v_add3_u32 v12, v146, v147, s86
    s_lshl_b32 s86, s75, 10
    s_add_u32 s86, s86, 4096
    v_lshl_add_u32 v15, v1, 2, s86
    s_lshl_b32 s87, s89, 13
    s_add_u32 s87, s87, 8192
    v_add_u32 v14, s87, v15
    s_lshl_b32 s86, s78, 6
    s_add_u32 s86, s86, 24576
    v_lshl_add_u32 v16, v5, 4, s86
    s_lshr_b32 s86, s75, 1
    s_mul_i32 s86, s86, 320
    s_and_b32 s87, s75, 1
    s_lshl_b32 s87, s87, 7
    s_add_u32 s86, s86, s87
    v_lshl_add_u32 v17, v1, 1, s86
    v_lshlrev_b32 v20, 4, v7
    v_lshl_add_u32 v19, v3, 2, v20
    s_lshl_b32 s86, s75, 6
    v_lshl_add_u32 v21, v3, 3, v21
    v_add_u32 v21, s86, v21
    v_and_b32 v146, 6, v2
    v_add_u32 v21, v21, v146
    v_lshrrev_b32 v146, 3, v2
    v_lshl_add_u32 v21, v146, 5, v21
    s_mov_b32 s34, 0xcccccccc
    s_mov_b32 s35, 0xcccccccc
    s_mov_b32 s36, 0xf0f0f0f0
    s_mov_b32 s37, 0xf0f0f0f0
    s_mov_b32 s38, 0xff00ff00
    s_mov_b32 s39, 0xff00ff00
    v_lshrrev_b32 v146, 1, v1
    s_lshl_b32 s86, s75, 5
    v_add_u32 v146, s86, v146
    s_lshl_b32 s86, s76, 1
    s_add_u32 s86, s86, s89
    s_mul_i32 s86, s86, 384
    s_lshl_b32 s87, s79, 14
    s_add_u32 s86, s86, s87
    v_lshl_add_u32 v25, v146, 2, s86
    s_and_b32 s86, s79, 1
    s_lshl_b32 s86, s86, 3
    v_subrev_u32 v146, s86, v146
    v_min_u32 v146, 71, v146
    v_mul_u32_u24 v146, 48, v146
    v_lshl_add_u32 v23, v7, 4, v146
    v_lshl_add_u32 v24, v7, 2, v146
    v_add_u32 v24, 32, v24
    s_cmp_lt_u32 s75, 3
    s_cselect_b64 s[98:99], s[100:101], 0
    s_cmp_eq_u32 s75, 2
    s_cselect_b64 s[100:101], 1, 0
    s_mul_i32 s87, s74, 4608
    s_add_u32 s87, s87, 111616
    v_add_u32 v125, s87, v125
    s_lshl_b32 s87, s74, 5
    v_and_b32 v150, 31, v1
    v_add_u32 v150, s87, v150
    v_lshlrev_b32 v34, 1, v150
    v_add_u32 v34, 154432, v34
    s_mul_i32 s86, s89, 1152
    v_lshl_add_u32 v150, v150, 2, s86
    v_lshrrev_b32 v151, 5, v1
    v_add_u32 v28, 62464, v150
    v_mul_u32_u24 v26, 9216, v151
    v_add_u32 v26, v26, v150
    v_add_u32 v26, 27648, v26
    v_add_u32 v27, 4608, v26
    v_lshlrev_b32 v29, 4, v5
    v_lshl_add_u32 v29, v151, 6, v29
    s_lshl_b32 s86, s89, 7
    s_add_u32 s86, s86, 24832
    v_add_u32 v29, s86, v29
    s_lshl_b32 s86, s74, 7
    s_add_u32 s86, s86, 44928
    v_lshl_add_u32 v30, v1, 1, s86
    v_lshlrev_b32 v31, 4, v3
    v_lshl_add_u32 v31, v7, 6, v31
    v_add_u32 v31, s86, v31
    s_lshl_b32 s86, s74, 2
    v_mul_u32_u24 v22, 48, v2
    v_add_u32 v22, s86, v22
    s_waitcnt lgkmcnt(0)
    s_add_u32 s32, s32, 1
    v_mov_b32 v7, 0xff
    s_barrier
    ds_read_b128 v[126:129], v10 offset:42496
    ds_read_b128 v[130:133], v10 offset:42560
    ds_read_b128 v[134:137], v10 offset:42624
    ds_read_b128 v[138:141], v10 offset:42688
    ds_read_b64 v[142:143], v11 offset:42752
    ds_read_b64_tr_b16 v[84:85], v89 offset:18432
    ds_read_b64_tr_b16 v[68:69], v105 offset:0
    ds_read_b64_tr_b16 v[70:71], v105 offset:576
    ds_read_b64_tr_b16 v[72:73], v105 offset:4608
    ds_read_b64_tr_b16 v[74:75], v105 offset:5184
    ds_read_b64_tr_b16 v[76:77], v105 offset:9216
    ds_read_b64_tr_b16 v[78:79], v105 offset:9792
    ds_read_b64_tr_b16 v[80:81], v105 offset:13824
    ds_read_b64_tr_b16 v[82:83], v105 offset:14400
    ds_read_u16 v32, v9 offset:42496
    ds_read_u16 v33, v33
    ds_read_u16 v34, v34
    s_waitcnt lgkmcnt(0)
    v_mfma_f32_16x16x32_bf16 v[146:149], v[68:71], v[126:129], 0
    v_mfma_f32_16x16x32_bf16 v[146:149], v[72:75], v[130:133], v[146:149]
    v_mfma_f32_16x16x32_bf16 v[146:149], v[76:79], v[134:137], v[146:149]
    v_mfma_f32_16x16x32_bf16 v[146:149], v[80:83], v[138:141], v[146:149]
    v_mfma_f32_16x16x32_bf16 v[146:149], v[84:87], v[142:145], v[146:149]
    v_lshlrev_b32 v32, 16, v32
    v_lshlrev_b32 v33, 16, v33
    v_lshlrev_b32 v34, 16, v34
    s_mov_b64 exec, s[94:95]
    s_nop 3
    v_bfi_b32 v130, v7, s32, v146
    v_bfi_b32 v131, v7, s32, v147
    v_bfi_b32 v132, v7, s32, v148
    v_bfi_b32 v133, v7, s32, v149
    buffer_store_dwordx4 v[130:133], v12, s[4:7], s81 offen
    s_mov_b64 exec, -1
    s_mov_b64 exec, 0
    s_branch T_Mg1
U_Mg1:
    s_mov_b64 exec, -1
    s_barrier
    buffer_load_dword v154, v14, s[4:7], s81 offen offset:0 sc1
    buffer_load_dword v155, v14, s[4:7], s81 offen offset:256 sc1
    buffer_load_dword v156, v14, s[4:7], s81 offen offset:512 sc1
    buffer_load_dword v157, v14, s[4:7], s81 offen offset:768 sc1
    buffer_load_dwordx4 v[158:161], v16, s[4:7], s81 offen sc1
    buffer_load_dword v126, v15, s[4:7], s81 offen offset:0 sc1
    buffer_load_dword v127, v15, s[4:7], s81 offen offset:256 sc1
    buffer_load_dword v128, v15, s[4:7], s81 offen offset:512 sc1
    buffer_load_dword v129, v15, s[4:7], s81 offen offset:768 sc1
    s_barrier
    v_xor_b32 v6, v2, v3
    v_lshlrev_b32 v6, 4, v6
    v_lshl_add_u32 v6, v2, 8, v6
    s_lshl_b32 s85, s75, 13
    s_add_u32 s85, s85, 78848
    v_add_u32 v6, s85, v6
    ds_read_b128 v[36:39], v6 offset:0
    ds_read_b128 v[52:55], v6 offset:4096
    v_xor_b32 v7, 64, v6
    ds_read_b128 v[40:43], v7 offset:0
    ds_read_b128 v[56:59], v7 offset:4096
    v_xor_b32 v7, 128, v6
    ds_read_b128 v[44:47], v7 offset:0
    ds_read_b128 v[60:63], v7 offset:4096
    v_xor_b32 v7, 192, v6
    ds_read_b128 v[48:51], v7 offset:0
    ds_read_b128 v[64:67], v7 offset:4096
    s_branch QW62
QR63:
    v_mov_b32 v7, 44864
VW64:
    ds_read_b32 v6, v7
    s_sub_u32 s84, s84, 1
    s_cbranch_scc1 L_END
    s_waitcnt lgkmcnt(0)
    v_cmp_eq_u32 vcc, -1, v6
    s_cbranch_vccnz VW64
    v_cmp_eq_u32 s[90:91], 0, v6
    v_cmp_ne_u32 s[92:93], 0, v6
    s_and_b64 exec, s[94:95], s[92:93]
    s_cbranch_execz QF65
    buffer_store_dwordx4 v[130:133], v12, s[4:7], s81 offen sc1
QF65:
    s_mov_b64 exec, -1
    s_sub_u32 s84, s84, 1
    s_cbranch_scc1 L_END
    buffer_load_dword v154, v14, s[4:7], s81 offen offset:0 sc1
    buffer_load_dword v155, v14, s[4:7], s81 offen offset:256 sc1
    buffer_load_dword v156, v14, s[4:7], s81 offen offset:512 sc1
    buffer_load_dword v157, v14, s[4:7], s81 offen offset:768 sc1
    buffer_load_dwordx4 v[158:161], v16, s[4:7], s81 offen sc1
    buffer_load_dword v126, v15, s[4:7], s81 offen offset:0 sc1
    buffer_load_dword v127, v15, s[4:7], s81 offen offset:256 sc1
    buffer_load_dword v128, v15, s[4:7], s81 offen offset:512 sc1
    buffer_load_dword v129, v15, s[4:7], s81 offen offset:768 sc1
QW62:
    s_waitcnt vmcnt(0)
    v_bitop3_b32 v4, v154, v155, s32 bitop3:0x7e
    v_bitop3_b32 v5, v156, v157, s32 bitop3:0x7e
    v_bitop3_b32 v6, v126, v127, s32 bitop3:0x7e
    v_bitop3_b32 v7, v128, v129, s32 bitop3:0x7e
    v_or3_b32 v4, v4, v5, v6
    v_or_b32 v4, v4, v7
    v_bitop3_b32 v5, v160, v161, s32 bitop3:0x7e
    v_and_b32 v4, 0xff, v4
    v_or_b32 v4, v4, v5
    v_cmp_ne_u32 vcc, 0, v4
    s_cbranch_vccnz QR63
    v_and_b32 v154, 0xffffff00, v154
    v_and_b32 v155, 0xffffff00, v155
    v_and_b32 v156, 0xffffff00, v156
    v_and_b32 v157, 0xffffff00, v157
    v_and_b32 v126, 0xffffff00, v126
    v_and_b32 v127, 0xffffff00, v127
    v_and_b32 v128, 0xffffff00, v128
    v_and_b32 v129, 0xffffff00, v129
    v_add_f32 v4, v126, v127
    v_add_f32 v5, v128, v129
    v_add_f32 v15, v4, v5
    v_add_f32_dpp v150, v158, v158 quad_perm:[1,0,3,2] row_mask:0xf bank_mask:0xf
    v_add_f32_dpp v151, v159, v159 quad_perm:[1,0,3,2] row_mask:0xf bank_mask:0xf
    v_add_f32 v146, v154, v155
    v_add_f32_dpp v150, v150, v150 quad_perm:[2,3,0,1] row_mask:0xf bank_mask:0xf
    v_add_f32_dpp v151, v151, v151 quad_perm:[2,3,0,1] row_mask:0xf bank_mask:0xf
    v_mul_f32 v4, 0x3ae38e39, v150
    v_fmamk_f32 v151, v151, 0x3ae38e39, v35
    v_fma_f32 v151, -v4, v4, v151
    v_max_f32 v151, v151, v35
    v_rsq_f32 v5, v151
    v_add_f32 v148, v156, v157
    v_add_f32 v146, v146, v148
    v_fma_f32 v146, -v4, v15, v146
    v_mul_f32 v5, 0x3e0293ee, v5
    v_mul_f32 v146, v146, v5
    v_cvt_pk_bf16_f32 v146, v146, v146
    ds_write_b16 v17, v146 offset:43520
    v_mov_b32 v7, 44864
VW66:
    ds_read_b32 v6, v7
    s_sub_u32 s84, s84, 1
    s_cbranch_scc1 L_END
    s_waitcnt lgkmcnt(0)
    v_cmp_eq_u32 vcc, -1, v6
    s_cbranch_vccnz VW66
    v_cmp_eq_u32 s[90:91], 0, v6
    v_cmp_ne_u32 s[92:93], 0, v6
    s_and_b64 exec, s[94:95], s[92:93]
    s_cbranch_execz QF67
    buffer_store_dwordx4 v[130:133], v12, s[4:7], s81 offen sc1
QF67:
    s_mov_b64 exec, -1
    s_branch B_Mg1
S_Mg2:
    v_and_b32 v146, 1, v3
    v_lshl_or_b32 v146, v146, 2, v6
    v_lshlrev_b32 v146, 5, v146
    s_lshl_b32 s86, s75, 6
    v_lshl_add_u32 v147, v5, 4, s86
    v_xor_b32 v146, v146, v147
    v_lshl_add_u32 v67, v4, 8, v146
    v_add_u32 v67, 46080, v67
    s_lshl_b32 s86, s75, 10
    s_lshl_b32 s87, s88, 4
    s_add_u32 s86, s86, s87
    s_add_u32 s86, s86, 54272
    v_lshlrev_b32 v146, 12, v7
    v_lshl_add_u32 v146, v3, 8, v146
    v_add_u32 v12, s86, v146
    s_lshr_b32 s86, s79, 2
    s_lshl_b32 s86, s86, 7
    s_lshl_b32 s87, s78, 4
    s_add_u32 s86, s86, s87
    s_add_u32 s86, s86, 24576
    v_lshl_add_u32 v14, v7, 6, s86
    s_and_b32 s79, s79, 3
    s_xor_b32 s86, s75, 1
    s_or_b32 s79, s79, s86
    s_mul_i32 s87, s74, 4608
    s_add_u32 s87, s87, 111616
    v_add_u32 v125, s87, v125
    s_lshl_b32 s87, s74, 5
    v_and_b32 v150, 31, v1
    v_add_u32 v150, s87, v150
    v_lshlrev_b32 v34, 1, v150
    v_add_u32 v34, 154432, v34
    s_mul_i32 s86, s89, 1152
    v_lshl_add_u32 v150, v150, 2, s86
    v_lshrrev_b32 v151, 5, v1
    v_add_u32 v28, 62464, v150
    v_mul_u32_u24 v26, 9216, v151
    v_add_u32 v26, v26, v150
    v_add_u32 v26, 27648, v26
    v_add_u32 v27, 4608, v26
    v_lshlrev_b32 v29, 4, v5
    v_lshl_add_u32 v29, v151, 6, v29
    s_lshl_b32 s86, s89, 7
    s_add_u32 s86, s86, 24832
    v_add_u32 v29, s86, v29
    s_lshl_b32 s86, s74, 7
    s_add_u32 s86, s86, 44928
    v_lshl_add_u32 v30, v1, 1, s86
    v_lshlrev_b32 v31, 4, v3
    v_lshl_add_u32 v31, v7, 6, v31
    v_add_u32 v31, s86, v31
    s_lshl_b32 s86, s74, 2
    v_mul_u32_u24 v22, 48, v2
    v_add_u32 v22, s86, v22
    s_waitcnt lgkmcnt(0)
    s_add_u32 s32, s32, 1
    v_mov_b32 v150, s32
    v_mov_b32 v151, s32
    s_barrier
    s_cmp_lg_u32 s79, 0
    s_cbranch_scc1 GS88
    ds_read_b128 v[126:129], v10 offset:42496
    ds_read_b128 v[130:133], v10 offset:42560
    ds_read_b128 v[134:137], v10 offset:42624
    ds_read_b128 v[138:141], v10 offset:42688
    ds_read_b64 v[142:143], v11 offset:42752
    v_cmp_eq_u32 vcc, 1, v1
    s_waitcnt lgkmcnt(4)
    v_mfma_f32_16x16x32_bf16 v[146:149], v[126:129], v[126:129], 0
    s_waitcnt lgkmcnt(3)
    v_mfma_f32_16x16x32_bf16 v[146:149], v[130:133], v[130:133], v[146:149]
    s_waitcnt lgkmcnt(2)
    v_mfma_f32_16x16x32_bf16 v[146:149], v[134:137], v[134:137], v[146:149]
    s_waitcnt lgkmcnt(1)
    v_mfma_f32_16x16x32_bf16 v[146:149], v[138:141], v[138:141], v[146:149]
    s_waitcnt lgkmcnt(0)
    v_mfma_f32_16x16x32_bf16 v[146:149], v[142:145], v[142:145], v[146:149]
    s_nop 7
    v_cndmask_b32 v149, v146, v147, vcc
    s_mov_b64 exec, 3
    buffer_store_dwordx4 v[148:151], v14, s[4:7], s81 offen
    s_mov_b64 exec, -1
GS88:
    ds_read_u16 v32, v9 offset:42496
    ds_read_u16 v33, v33
    ds_read_u16 v34, v34
    s_mov_b64 exec, 0
    s_branch T_Mg2
U_Mg2:
    s_mov_b64 exec, -1
    s_barrier
    s_barrier
    v_mov_b32 v7, 44864
VW89:
    ds_read_b32 v6, v7
    s_sub_u32 s84, s84, 1
    s_cbranch_scc1 L_END
    s_waitcnt lgkmcnt(0)
    v_cmp_eq_u32 vcc, -1, v6
    s_cbranch_vccnz VW89
    v_cmp_eq_u32 s[90:91], 0, v6
    v_cmp_ne_u32 s[92:93], 0, v6
    v_lshlrev_b32 v32, 16, v32
    v_lshlrev_b32 v33, 16, v33
    v_lshlrev_b32 v34, 16, v34
    s_cmp_lg_u32 s79, 0
    s_cbranch_scc1 QF90
    s_and_b64 exec, 3, s[92:93]
    s_cbranch_execz QF90
    buffer_store_dwordx4 v[148:151], v14, s[4:7], s81 offen sc1
QF90:
    s_mov_b64 exec, -1
    s_branch B_Mg2
S_Max:
    s_lshl_b32 s86, 4, 5
    v_add_u32 v105, s86, v125
    v_lshl_add_u32 v89, v3, 2, v6
    v_mul_u32_u24 v89, 144, v89
    v_lshl_add_u32 v89, v5, 3, v89
    v_add_u32 v89, s86, v89
    v_mov_b32 v86, 0
    v_mov_b32 v87, 0
    s_lshl_b32 s86, 4, 6
    v_lshl_add_u32 v146, v3, 4, s86
    v_cmp_eq_u32 vcc, 2, v2
    v_mul_u32_u24 v147, 9216, v2
    v_add_u32 v147, 27648, v147
    v_mov_b32 v148, 62464
    v_cndmask_b32 v147, v147, v148, vcc
    s_mul_i32 s86, s79, 288
    s_mul_i32 s87, s78, 2304
    s_add_u32 s86, s86, s87
    v_add3_u32 v13, v146, v147, s86
    s_mov_b32 s95, 0
    s_mov_b32 s97, 0
    v_lshrrev_b32 v151, 5, v1
    v_and_b32 v150, 31, v1
    v_mul_u32_u24 v14, 320, v151
    v_lshl_add_u32 v14, v150, 3, v14
    v_lshlrev_b32 v20, 4, v151
    s_lshl_b32 s86, s88, 3
    s_add_u32 s86, s86, 25344
    v_lshl_add_u32 v12, v151, 7, s86
    s_mov_b32 s98, 1
    s_mov_b32 s99, 1
    s_mul_i32 s87, s74, 4608
    s_add_u32 s87, s87, 111616
    v_add_u32 v125, s87, v125
    s_lshl_b32 s87, s74, 5
    v_and_b32 v150, 31, v1
    v_add_u32 v150, s87, v150
    v_lshlrev_b32 v34, 1, v150
    v_add_u32 v34, 154432, v34
    s_mul_i32 s86, s89, 1152
    v_lshl_add_u32 v150, v150, 2, s86
    v_lshrrev_b32 v151, 5, v1
    v_add_u32 v28, 62464, v150
    v_mul_u32_u24 v26, 9216, v151
    v_add_u32 v26, v26, v150
    v_add_u32 v26, 27648, v26
    v_add_u32 v27, 4608, v26
    v_lshlrev_b32 v29, 4, v5
    v_lshl_add_u32 v29, v151, 6, v29
    s_lshl_b32 s86, s89, 7
    s_add_u32 s86, s86, 24832
    v_add_u32 v29, s86, v29
    s_lshl_b32 s86, s74, 7
    s_add_u32 s86, s86, 44928
    v_lshl_add_u32 v30, v1, 1, s86
    v_lshlrev_b32 v31, 4, v3
    v_lshl_add_u32 v31, v7, 6, v31
    v_add_u32 v31, s86, v31
    s_lshl_b32 s86, s74, 2
    v_mul_u32_u24 v22, 48, v2
    v_add_u32 v22, s86, v22
    s_waitcnt lgkmcnt(0)
    s_add_u32 s32, s32, 1
    s_getreg_b32 s87, hwreg(HW_REG_XCC_ID, 0, 4)
    s_mul_i32 s30, s32, 0x9e3779b1
    s_andn2_b32 s30, s30, 15
    s_or_b32 s30, s30, s87
    v_mov_b32 v45, s30
    s_add_u32 s31, s81, 130816
    s_lshl_b32 s86, s77, 2
    s_add_u32 s28, s31, s86
    v_and_b32 v42, 31, v1
    v_lshlrev_b32 v42, 2, v42
    s_mov_b64 exec, 1
    s_waitcnt vmcnt(0)
    buffer_store_dword v45, off, s[4:7], s28
    s_mov_b64 exec, -1
    s_barrier
    ds_read_u16 v32, v9 offset:42496
    ds_read_u16 v33, v33
    ds_read_u16 v34, v34
    s_mov_b32 s29, 3
    s_mov_b64 exec, 0
    s_branch T_Max
U_Max:
    s_mov_b64 exec, -1
    s_barrier
    buffer_load_dword v43, v42, s[4:7], s31 offen sc1
    s_barrier
    v_mov_b32 v150, 0
    v_mov_b32 v151, 0
    v_mov_b32 v152, 0
    v_mov_b32 v153, 0
    ds_write_b128 v40, v[150:153] offset:0
    ds_write_b128 v40, v[150:153] offset:1024
    ds_write_b128 v40, v[150:153] offset:2048
    ds_write_b128 v40, v[150:153] offset:3072
    ds_write_b128 v40, v[150:153] offset:4096
    ds_write_b128 v40, v[150:153] offset:5120
    ds_write_b128 v40, v[150:153] offset:6144
    ds_write_b128 v40, v[150:153] offset:7168
    s_waitcnt lgkmcnt(0)
    v_lshlrev_b32 v32, 16, v32
    v_lshlrev_b32 v33, 16, v33
    v_lshlrev_b32 v34, 16, v34
FL110:
    s_mov_b32 s86, 0
    s_waitcnt vmcnt(0)
    v_xor_b32 v4, v45, v43
    v_cmp_ne_u32 vcc, 0, v4
    s_cbranch_vccz FL111
    v_cmp_lt_u32 s[92:93], 15, v4
    s_sub_u32 s29, s29, 1
    s_max_i32 s29, s29, 0
    s_cmp_eq_u64 vcc, s[92:93]
    s_cselect_b32 s87, s29, 0
    s_cmp_lg_u32 s87, 0
    s_cbranch_scc1 FL114
    s_mov_b64 exec, 1
    buffer_store_dword v45, off, s[4:7], s28 sc1
    s_mov_b64 exec, -1
    s_mov_b32 s86, 1
    s_cmp_eq_u64 s[92:93], 0
    s_cbranch_scc1 FL111
FL114:
    s_sub_u32 s84, s84, 1
    s_cbranch_scc1 L_END
    buffer_load_dword v43, v42, s[4:7], s31 offen sc1
    s_branch FL110
FL111:
    s_lshl_b32 s28, s76, 2
    v_mov_b32 v4, s86
    v_mov_b32 v5, 44864
    ds_write_b32 v5, v4
    v_cmp_eq_u32 s[90:91], 0, v4
    v_cmp_ne_u32 s[92:93], 0, v4
    s_cmp_eq_u32 s86, 0
    s_cbranch_scc1 FL113
    s_mul_i32 s85, s77, 1536
    s_add_u32 s85, s85, s81
    s_add_u32 s85, s85, 24832
    buffer_store_dwordx4 v[36:39], v40, s[4:7], s85 offen offset:0 sc1
    s_mov_b32 exec_hi, 0
    buffer_store_dwordx4 v[36:39], v40, s[4:7], s85 offen offset:1024 sc1
    s_mov_b64 exec, -1
    s_mov_b32 s29, 1
    s_waitcnt vmcnt(0)
    s_atomic_add s29, s[46:47], s28
FL112:
    s_load_dword s86, s[46:47], s28 glc
    s_sub_u32 s84, s84, 1
    s_cbranch_scc1 L_END
    s_waitcnt lgkmcnt(0)
    s_cmp_lt_u32 s86, 32
    s_cbranch_scc1 FL112
FL113:
    s_cmp_lg_u32 s77, 16
    s_cbranch_scc1 FL115
    s_mov_b32 s31, -1
    s_add_u32 s30, s28, 128
    s_atomic_or s31, s[46:47], s30
FL115:
    s_lshl_b32 s85, s77, 9
    s_add_u32 s85, s85, 46080
    s_min_u32 s86, s77, 19
    s_lshl_b32 s86, s86, 7
    s_add_u32 s86, s86, 25088
    v_lshl_add_u32 v4, v1, 7, s85
    v_writelane_b32 v4, s86, 4
    s_mov_b64 exec, 31
    buffer_load_dword v41, v4, s[4:7], s81 offen sc1
    s_mov_b64 exec, -1
    s_branch B_Max
L_END:
    s_endpgm
    .p2align 12
T_Og1:
    s_branch T_Og1_1
B_Og1:
    s_waitcnt lgkmcnt(0)
    s_barrier
    ds_read_b128 v[126:129], v18 offset:43520
    ds_read_b128 v[130:133], v18 offset:43584
    ds_read_b128 v[134:137], v18 offset:43648
    ds_read_b128 v[138:141], v18 offset:43712
    s_waitcnt lgkmcnt(3)
    v_mfma_f32_16x16x32_bf16 v[146:149], v[36:39], v[126:129], 0
    v_mfma_f32_16x16x32_bf16 v[150:153], v[52:55], v[126:129], 0
    s_waitcnt lgkmcnt(2)
    v_mfma_f32_16x16x32_bf16 v[146:149], v[40:43], v[130:133], v[146:149]
    v_mfma_f32_16x16x32_bf16 v[150:153], v[56:59], v[130:133], v[150:153]
    s_waitcnt lgkmcnt(1)
    v_mfma_f32_16x16x32_bf16 v[146:149], v[44:47], v[134:137], v[146:149]
    v_mfma_f32_16x16x32_bf16 v[150:153], v[60:63], v[134:137], v[150:153]
    s_waitcnt lgkmcnt(0)
    v_mfma_f32_16x16x32_bf16 v[146:149], v[48:51], v[138:141], v[146:149]
    v_mfma_f32_16x16x32_bf16 v[150:153], v[64:67], v[138:141], v[150:153]
    s_mov_b64 exec, s[96:97]
    s_nop 5
    v_max3_f32 v4, v146, v147, v148
    v_max3_f32 v5, v150, v151, v152
    v_max3_f32 v4, v4, v149, v153
    v_max_f32 v4, v4, v5
    ds_max_f32 v19, v4 offset:44800
    s_mov_b64 exec, -1
    v_cndmask_b32 v146, v146, v150, s[38:39]
    v_cndmask_b32 v147, v147, v151, s[38:39]
    v_cndmask_b32 v148, v148, v152, s[38:39]
    v_cndmask_b32 v149, v149, v153, s[38:39]
    v_cndmask_b32 v146, v146, v148, s[36:37]
    v_cndmask_b32 v147, v147, v149, s[36:37]
    v_cndmask_b32 v146, v146, v147, s[34:35]
    s_waitcnt lgkmcnt(0)
    s_barrier
    ds_read_b128 v[142:145], v20 offset:44800
    s_waitcnt lgkmcnt(0)
    v_max3_f32 v4, v142, v143, v144
    v_max_f32 v4, v4, v145
    v_sub_f32 v146, v146, v4
    v_exp_f32 v146, v146
    s_nop 0
    v_cvt_pk_bf16_f32 v146, v146, v146
    ds_write_b16 v21, v146 offset:44160
    s_waitcnt lgkmcnt(0)
    s_barrier
    s_barrier
    s_barrier
    s_mov_b32 s83, 1048576
    s_mov_b32 s86, 1056768
    s_mov_b32 s85, 1310720
    s_mov_b32 s87, 1318912
    v_mov_b32 v7, -1
    s_waitcnt lgkmcnt(0)
    s_barrier
    ds_read_b128 v[146:149], v23 offset:0
    ds_read_b128 v[150:153], v23 offset:3840
    s_waitcnt lgkmcnt(1)
    v_pk_add_f32 v[146:147], v[146:147], v[148:149]
    s_waitcnt lgkmcnt(0)
    v_pk_add_f32 v[150:151], v[150:151], v[152:153]
    v_add_f32 v146, v146, v147
    v_add_f32 v147, v150, v151
    s_nop 0
    v_add_f32_dpp v146, v146, v146 quad_perm:[1,0,3,2] row_mask:0xf bank_mask:0xf
    v_add_f32_dpp v147, v147, v147 quad_perm:[1,0,3,2] row_mask:0xf bank_mask:0xf
    s_mov_b64 exec, s[98:99]
    v_cvt_pk_bf16_f32 v146, v146, v147
    buffer_store_dword v146, v25, s[4:7], s86 offen sc1
    buffer_store_dword v146, v25, s[4:7], s83 offen sc1
    buffer_store_dword v7, v25, s[4:7], s85 offen sc1
    buffer_store_dword v7, v25, s[4:7], s87 offen sc1
    s_mov_b64 exec, -1
    v_mov_b32 v142, 0
    v_mov_b32 v143, 0
    v_mov_b32 v4, 44872
    ds_read_b64 v[152:153], v4
    v_or_b32 v5, 8192, v8
    v_and_b32 v8, 0xffffdfff, v8
    s_waitcnt lgkmcnt(0)
    v_cmp_lt_u32 vcc, v153, v152
    s_nop 1
    v_cndmask_b32 v8, v8, v5, vcc
    ds_read_b64_tr_b16 v[88:89], v89 offset:39680
    ds_read_b64_tr_b16 v[90:91], v105 offset:21248
    ds_read_b64_tr_b16 v[92:93], v105 offset:21824
    ds_read_b64_tr_b16 v[94:95], v105 offset:25856
    ds_read_b64_tr_b16 v[96:97], v105 offset:26432
    ds_read_b64_tr_b16 v[98:99], v105 offset:30464
    ds_read_b64_tr_b16 v[100:101], v105 offset:31040
    ds_read_b64_tr_b16 v[102:103], v105 offset:35072
    ds_read_b64_tr_b16 v[104:105], v105 offset:35648
    ds_read_b128 v[126:129], v10 offset:42496
    ds_read_b128 v[130:133], v10 offset:42560
    ds_read_b128 v[134:137], v10 offset:42624
    ds_read_b128 v[138:141], v10 offset:42688
    ds_read_b64 v[144:145], v11 offset:42752
    s_waitcnt lgkmcnt(4)
    v_mfma_f32_16x16x32_bf16 v[146:149], v[90:93], v[126:129], 0
    s_waitcnt lgkmcnt(3)
    v_mfma_f32_16x16x32_bf16 v[146:149], v[94:97], v[130:133], v[146:149]
    s_waitcnt lgkmcnt(2)
    v_mfma_f32_16x16x32_bf16 v[146:149], v[98:101], v[134:137], v[146:149]
    s_waitcnt lgkmcnt(1)
    v_mfma_f32_16x16x32_bf16 v[146:149], v[102:105], v[138:141], v[146:149]
    s_waitcnt lgkmcnt(0)
    v_mfma_f32_16x16x32_bf16 v[146:149], v[86:89], v[142:145], v[146:149]
    s_andn2_b64 s[94:95], s[94:95], s[96:97]
    s_and_b64 exec, s[94:95], s[90:91]
    s_nop 5
    buffer_store_dwordx4 v[146:149], v13, s[4:7], s81 offen
    s_and_b64 exec, s[94:95], s[92:93]
    buffer_store_dwordx4 v[146:149], v13, s[4:7], s81 offen sc1
    s_mov_b64 exec, -1
    s_barrier
    s_mov_b32 s83, 1048576
    s_mov_b64 vcc, -1
XG7:
    s_mov_b64 exec, vcc
    buffer_load_dwordx4 v[154:157], v8, s[4:7], s83 offen sc1
    s_mov_b64 exec, -1
    s_sub_u32 s84, s84, 1
    s_cbranch_scc1 L_END
T_Og1_1:
    s_cbranch_execz T_Og1_2
    s_waitcnt vmcnt(0)
XW8:
    v_mfma_f32_16x16x32_bf16 v[146:149], v[154:157], v[164:167], 0
    v_max3_u32 v4, v154, v155, v156
    v_max_u32 v4, v4, v157
    v_cmp_eq_u32 vcc, -1, v4
    s_nop 1
    s_cbranch_vccnz XG7
    s_nop 1
    v_permlane32_swap_b32 v146, v147
    v_permlane32_swap_b32 v148, v149
    v_add_f32 v146, v146, v147
    v_add_f32 v148, v148, v149
    s_nop 1
    v_permlane16_swap_b32 v146, v148
    v_add_f32 v146, v146, v32
    v_add_f32 v146, v146, v148
    v_cvt_pk_bf16_f32 v146, v146, v146
    ds_write_b16 v9, v146 offset:42496
    v_lshlrev_b32 v32, 16, v146
    v_add_f32 v32, v32, v33
    s_waitcnt lgkmcnt(0)
    s_barrier
    ds_read_b128 v[126:129], v10 offset:42496
    ds_read_b128 v[130:133], v10 offset:42560
    ds_read_b128 v[134:137], v10 offset:42624
    ds_read_b128 v[138:141], v10 offset:42688
    ds_read_b64 v[144:145], v11 offset:42752
    s_waitcnt lgkmcnt(4)
    v_mfma_f32_16x16x32_bf16 v[146:149], v[90:93], v[126:129], 0
    s_waitcnt lgkmcnt(3)
    v_mfma_f32_16x16x32_bf16 v[146:149], v[94:97], v[130:133], v[146:149]
    s_waitcnt lgkmcnt(2)
    v_mfma_f32_16x16x32_bf16 v[146:149], v[98:101], v[134:137], v[146:149]
    s_waitcnt lgkmcnt(1)
    v_mfma_f32_16x16x32_bf16 v[146:149], v[102:105], v[138:141], v[146:149]
    s_waitcnt lgkmcnt(0)
    v_mfma_f32_16x16x32_bf16 v[146:149], v[86:89], v[142:145], v[146:149]
    s_and_b64 exec, s[96:97], s[90:91]
    s_nop 6
    buffer_store_dwordx4 v[146:149], v13, s[4:7], s81 offen
    s_and_b64 exec, s[96:97], s[92:93]
    buffer_store_dwordx4 v[146:149], v13, s[4:7], s81 offen sc1
    s_mov_b64 exec, -1
    s_barrier
    s_andn2_b32 s86, s33, 8192
    s_or_b32 s87, s33, 8192
    v_mov_b32 v4, 0
    s_memtime s[24:25]
    s_load_dword s30, s[72:73], s86 glc
    s_waitcnt lgkmcnt(0)
    s_memtime s[26:27]
    s_load_dword s30, s[72:73], s87 glc
    s_waitcnt lgkmcnt(0)
    s_memtime s[28:29]
    s_sub_u32 s86, s26, s24
    v_mov_b32 v5, s86
    s_waitcnt lgkmcnt(0)
    s_sub_u32 s87, s28, s26
    v_mov_b32 v6, s87
    s_mov_b64 exec, 1
    ds_min_u32 v4, v5 offset:44872
    ds_min_u32 v4, v6 offset:44876
    s_mov_b64 exec, -1
    v_mov_b32 v144, 0
    v_mov_b32 v145, 0
    s_mov_b32 s83, 1179648
    s_mov_b64 exec, 1
HW9:
    buffer_load_dword v4, off, s[4:7], s80 offset:1024 sc1
    s_sub_u32 s84, s84, 1
    s_cbranch_scc1 L_END
T_Og1_2:
    s_cbranch_execz T_Og1_3
    s_waitcnt vmcnt(0)
    v_cmp_eq_u32 vcc, -1, v4
    s_cbranch_vccnz HW9
    s_mov_b64 exec, -1
    v_mov_b32 v4, 44872
    ds_read_b64 v[152:153], v4
    v_or_b32 v5, 8192, v8
    v_and_b32 v8, 0xffffdfff, v8
    s_waitcnt lgkmcnt(0)
    v_cmp_lt_u32 vcc, v153, v152
    s_nop 1
    v_cndmask_b32 v8, v8, v5, vcc
    s_add_u32 s80, s80, 63488
    s_mov_b64 vcc, -1
XG10:
    s_mov_b64 exec, vcc
    buffer_load_dwordx4 v[154:157], v8, s[4:7], s83 offen sc1
    s_mov_b64 exec, -1
    s_sub_u32 s84, s84, 1
    s_cbranch_scc1 L_END
T_Og1_3:
    s_cbranch_execz T_Og1_4
    s_waitcnt vmcnt(0)
XW11:
    v_mfma_f32_16x16x32_bf16 v[146:149], v[154:157], v[164:167], 0
    v_max3_u32 v4, v154, v155, v156
    v_max_u32 v4, v4, v157
    v_cmp_eq_u32 vcc, -1, v4
    s_nop 1
    s_cbranch_vccnz XG10
    s_nop 1
    v_permlane32_swap_b32 v146, v147
    v_permlane32_swap_b32 v148, v149
    v_add_f32 v146, v146, v147
    v_add_f32 v148, v148, v149
    s_nop 1
    v_permlane16_swap_b32 v146, v148
    v_add_f32 v146, v146, v32
    v_add_f32 v146, v146, v148
    v_cvt_pk_bf16_f32 v146, v146, v146
    ds_write_b16 v9, v146 offset:42496
    v_lshlrev_b32 v32, 16, v146
    s_waitcnt lgkmcnt(0)
    s_barrier
    ds_read_b128 v[126:129], v10 offset:42496
    ds_read_b128 v[130:133], v10 offset:42560
    ds_read_b128 v[134:137], v10 offset:42624
    ds_read_b128 v[138:141], v10 offset:42688
    ds_read_b64 v[142:143], v11 offset:42752
    s_waitcnt lgkmcnt(4)
    v_mfma_f32_16x16x32_bf16 v[146:149], v[68:71], v[126:129], 0
    s_waitcnt lgkmcnt(3)
    v_mfma_f32_16x16x32_bf16 v[146:149], v[72:75], v[130:133], v[146:149]
    s_waitcnt lgkmcnt(2)
    v_mfma_f32_16x16x32_bf16 v[146:149], v[76:79], v[134:137], v[146:149]
    s_waitcnt lgkmcnt(1)
    v_mfma_f32_16x16x32_bf16 v[146:149], v[80:83], v[138:141], v[146:149]
    s_waitcnt lgkmcnt(0)
    v_mfma_f32_16x16x32_bf16 v[146:149], v[84:87], v[142:145], v[146:149]
    s_and_b64 exec, s[96:97], s[90:91]
    s_nop 6
    buffer_store_dwordx4 v[146:149], v12, s[4:7], s82 offen
    s_and_b64 exec, s[96:97], s[92:93]
    buffer_store_dwordx4 v[146:149], v12, s[4:7], s82 offen sc1
    s_mov_b64 exec, -1
    s_barrier
    buffer_load_dword v154, v14, s[4:7], s82 offen offset:0 sc1
    buffer_load_dword v155, v14, s[4:7], s82 offen offset:256 sc1
    buffer_load_dword v156, v14, s[4:7], s82 offen offset:512 sc1
    buffer_load_dword v157, v14, s[4:7], s82 offen offset:768 sc1
    buffer_load_dwordx2 v[158:159], v16, s[4:7], s82 offen sc1
    v_mov_b32 v4, 44872
    ds_read_b64 v[152:153], v4
    v_or_b32 v5, 8192, v8
    v_and_b32 v8, 0xffffdfff, v8
    s_waitcnt lgkmcnt(0)
    v_cmp_lt_u32 vcc, v153, v152
    s_nop 1
    v_cndmask_b32 v8, v8, v5, vcc
PG12:
    buffer_load_dword v154, v14, s[4:7], s82 offen offset:0 sc1
    buffer_load_dword v155, v14, s[4:7], s82 offen offset:256 sc1
    buffer_load_dword v156, v14, s[4:7], s82 offen offset:512 sc1
    buffer_load_dword v157, v14, s[4:7], s82 offen offset:768 sc1
    buffer_load_dwordx2 v[158:159], v16, s[4:7], s82 offen sc1
    s_sub_u32 s84, s84, 1
    s_cbranch_scc1 L_END
T_Og1_4:
    s_cbranch_execz T_Og1_5
PW13:
    s_waitcnt vmcnt(5)
    v_max3_u32 v4, v154, v155, v156
    v_max3_u32 v4, v157, v159, v4
    v_max_u32 v4, v4, v158
    v_cmp_eq_u32 vcc, -1, v4
    v_add_f32_dpp v150, v158, v158 quad_perm:[1,0,3,2] row_mask:0xf bank_mask:0xf
    v_add_f32_dpp v151, v159, v159 quad_perm:[1,0,3,2] row_mask:0xf bank_mask:0xf
    v_add_f32 v146, v154, v155
    v_add_f32_dpp v150, v150, v150 quad_perm:[2,3,0,1] row_mask:0xf bank_mask:0xf
    v_add_f32_dpp v151, v151, v151 quad_perm:[2,3,0,1] row_mask:0xf bank_mask:0xf
    s_cbranch_vccnz PG12
    v_mul_f32 v4, 0x3ae38e39, v150
    v_fmamk_f32 v151, v151, 0x3ae38e39, v35
    v_fma_f32 v151, -v4, v4, v151
    v_max_f32 v151, v151, v35
    v_rsq_f32 v5, v151
    v_add_f32 v148, v156, v157
    v_add_f32 v146, v146, v148
    v_fma_f32 v146, -v4, v15, v146
    v_mul_f32 v5, 0x3e0293ee, v5
    v_mul_f32 v146, v146, v5
    v_cvt_pk_bf16_f32 v146, v146, v146
    ds_write_b16 v17, v146 offset:43520
    s_waitcnt lgkmcnt(0)
    s_barrier
    ds_read_b128 v[126:129], v18 offset:43520
    ds_read_b128 v[130:133], v18 offset:43584
    ds_read_b128 v[134:137], v18 offset:43648
    ds_read_b128 v[138:141], v18 offset:43712
    s_waitcnt lgkmcnt(3)
    v_mfma_f32_16x16x32_bf16 v[146:149], v[36:39], v[126:129], 0
    v_mfma_f32_16x16x32_bf16 v[150:153], v[52:55], v[126:129], 0
    s_waitcnt lgkmcnt(2)
    v_mfma_f32_16x16x32_bf16 v[146:149], v[40:43], v[130:133], v[146:149]
    v_mfma_f32_16x16x32_bf16 v[150:153], v[56:59], v[130:133], v[150:153]
    s_waitcnt lgkmcnt(1)
    v_mfma_f32_16x16x32_bf16 v[146:149], v[44:47], v[134:137], v[146:149]
    v_mfma_f32_16x16x32_bf16 v[150:153], v[60:63], v[134:137], v[150:153]
    s_waitcnt lgkmcnt(0)
    v_mfma_f32_16x16x32_bf16 v[146:149], v[48:51], v[138:141], v[146:149]
    v_mfma_f32_16x16x32_bf16 v[150:153], v[64:67], v[138:141], v[150:153]
    s_mov_b64 exec, s[96:97]
    s_nop 5
    v_max3_f32 v4, v146, v147, v148
    v_max3_f32 v5, v150, v151, v152
    v_max3_f32 v4, v4, v149, v153
    v_max_f32 v4, v4, v5
    ds_max_f32 v19, v4 offset:44832
    s_mov_b64 exec, -1
    v_cndmask_b32 v146, v146, v150, s[38:39]
    v_cndmask_b32 v147, v147, v151, s[38:39]
    v_cndmask_b32 v148, v148, v152, s[38:39]
    v_cndmask_b32 v149, v149, v153, s[38:39]
    v_cndmask_b32 v146, v146, v148, s[36:37]
    v_cndmask_b32 v147, v147, v149, s[36:37]
    v_cndmask_b32 v146, v146, v147, s[34:35]
    s_waitcnt lgkmcnt(0)
    s_barrier
    ds_read_b128 v[142:145], v20 offset:44832
    s_waitcnt lgkmcnt(0)
    v_max3_f32 v4, v142, v143, v144
    v_max_f32 v4, v4, v145
    v_sub_f32 v146, v146, v4
    v_exp_f32 v146, v146
    s_nop 0
    v_cvt_pk_bf16_f32 v146, v146, v146
    ds_write_b16 v21, v146 offset:44160
    s_waitcnt lgkmcnt(0)
    s_barrier
    s_barrier
    s_mov_b32 s83, 1310720
    s_mov_b32 s86, 1318912
    s_waitcnt lgkmcnt(0)
    s_barrier
    ds_read_b128 v[146:149], v23 offset:0
    ds_read_b128 v[150:153], v23 offset:3840
    s_waitcnt lgkmcnt(1)
    v_pk_add_f32 v[146:147], v[146:147], v[148:149]
    s_waitcnt lgkmcnt(0)
    v_pk_add_f32 v[150:151], v[150:151], v[152:153]
    v_add_f32 v146, v146, v147
    v_add_f32 v147, v150, v151
    s_nop 0
    v_add_f32_dpp v146, v146, v146 quad_perm:[1,0,3,2] row_mask:0xf bank_mask:0xf
    v_add_f32_dpp v147, v147, v147 quad_perm:[1,0,3,2] row_mask:0xf bank_mask:0xf
    s_mov_b64 exec, s[98:99]
    v_cvt_pk_bf16_f32 v146, v146, v147
    buffer_store_dword v146, v25, s[4:7], s86 offen sc1
    buffer_store_dword v146, v25, s[4:7], s83 offen sc1
    s_and_b64 exec, s[100:101], s[90:91]
    buffer_store_dword v1, off, s[4:7], s80 offset:0
    s_and_b64 exec, s[100:101], s[92:93]
    buffer_store_dword v1, off, s[4:7], s80 offset:0 sc1
    s_mov_b64 exec, -1
    s_mov_b64 exec, s[98:99]
    s_mov_b64 exec, -1
    s_barrier
    v_mov_b32 v142, 0
    v_mov_b32 v143, 0
    s_mov_b32 s83, 1310720
    s_barrier
    s_mov_b64 vcc, -1
XG14:
    s_mov_b64 exec, vcc
    buffer_load_dwordx4 v[154:157], v8, s[4:7], s83 offen sc1
    s_mov_b64 exec, -1
    s_sub_u32 s84, s84, 1
    s_cbranch_scc1 L_END
T_Og1_5:
    s_cbranch_execz T_Og1_6
    s_waitcnt vmcnt(0)
XW15:
    v_mfma_f32_16x16x32_bf16 v[146:149], v[154:157], v[164:167], 0
    v_max3_u32 v4, v154, v155, v156
    v_max_u32 v4, v4, v157
    v_cmp_eq_u32 vcc, -1, v4
    s_nop 1
    s_cbranch_vccnz XG14
    s_nop 1
    v_permlane32_swap_b32 v146, v147
    v_permlane32_swap_b32 v148, v149
    v_add_f32 v146, v146, v147
    v_add_f32 v148, v148, v149
    s_nop 1
    v_permlane16_swap_b32 v146, v148
    v_add_f32 v146, v146, v32
    v_add_f32 v146, v146, v148
    v_cvt_pk_bf16_f32 v146, v146, v146
    ds_write_b16 v9, v146 offset:42496
    v_lshlrev_b32 v32, 16, v146
    v_add_f32 v32, v32, v33
    s_waitcnt lgkmcnt(0)
    s_barrier
    ds_read_b128 v[126:129], v10 offset:42496
    ds_read_b128 v[130:133], v10 offset:42560
    ds_read_b128 v[134:137], v10 offset:42624
    ds_read_b128 v[138:141], v10 offset:42688
    ds_read_b64 v[144:145], v11 offset:42752
    s_waitcnt lgkmcnt(4)
    v_mfma_f32_16x16x32_bf16 v[146:149], v[90:93], v[126:129], 0
    s_waitcnt lgkmcnt(3)
    v_mfma_f32_16x16x32_bf16 v[146:149], v[94:97], v[130:133], v[146:149]
    s_waitcnt lgkmcnt(2)
    v_mfma_f32_16x16x32_bf16 v[146:149], v[98:101], v[134:137], v[146:149]
    s_waitcnt lgkmcnt(1)
    v_mfma_f32_16x16x32_bf16 v[146:149], v[102:105], v[138:141], v[146:149]
    s_waitcnt lgkmcnt(0)
    v_mfma_f32_16x16x32_bf16 v[146:149], v[86:89], v[142:145], v[146:149]
    s_and_b64 exec, s[96:97], s[90:91]
    s_nop 6
    buffer_store_dwordx4 v[146:149], v13, s[4:7], s82 offen
    s_and_b64 exec, s[96:97], s[92:93]
    buffer_store_dwordx4 v[146:149], v13, s[4:7], s82 offen sc1
    s_mov_b64 exec, -1
    s_barrier
    s_and_b32 s85, s2, 63
    s_cbranch_scc0 GO16
    s_endpgm
GO16:
    v_and_b32 v4, 1, v1
    v_mul_u32_u24 v4, 832, v4
    s_mul_i32 s85, s78, 288
    v_add3_u32 v9, v9, v4, s85
    s_mov_b32 s83, 1441792
    s_mov_b64 exec, 1
HW17:
    buffer_load_dword v4, off, s[4:7], s80 offset:1024 sc1
    s_sub_u32 s84, s84, 1
    s_cbranch_scc1 L_END
T_Og1_6:
    s_cbranch_execz T_Og1_7
    s_waitcnt vmcnt(0)
    v_cmp_eq_u32 vcc, -1, v4
    s_cbranch_vccnz HW17
    s_mov_b64 exec, -1
    v_mov_b32 v4, 44872
    ds_read_b64 v[152:153], v4
    v_or_b32 v5, 8192, v8
    v_and_b32 v8, 0xffffdfff, v8
    s_waitcnt lgkmcnt(0)
    v_cmp_lt_u32 vcc, v153, v152
    s_nop 1
    v_cndmask_b32 v8, v8, v5, vcc
    s_mov_b64 vcc, -1
XG18:
    s_mov_b64 exec, vcc
    buffer_load_dwordx4 v[154:157], v8, s[4:7], s83 offen sc1
    s_mov_b64 exec, -1
    s_sub_u32 s84, s84, 1
    s_cbranch_scc1 L_END
T_Og1_7:
    s_cbranch_execz T_Og1_8
    s_waitcnt vmcnt(0)
XW19:
    v_mfma_f32_16x16x32_bf16 v[146:149], v[154:157], v[164:167], 0
    v_max3_u32 v4, v154, v155, v156
    v_max_u32 v4, v4, v157
    v_cmp_eq_u32 vcc, -1, v4
    s_nop 1
    s_cbranch_vccnz XG18
    s_nop 1
    v_permlane32_swap_b32 v146, v147
    v_permlane32_swap_b32 v148, v149
    v_add_f32 v146, v146, v147
    v_add_f32 v148, v148, v149
    s_nop 1
    v_permlane16_swap_b32 v146, v148
    v_add_f32 v146, v146, v32
    v_add_f32 v146, v146, v148
    v_cvt_pk_bf16_f32 v146, v146, v146
    buffer_store_short v146, v9, s[8:11], 0 offen
    s_endpgm
T_Og1_8:
    s_branch U_Og1
    .p2align 12
T_Og2:
    s_branch T_Og2_1
B_Og2:
    s_waitcnt lgkmcnt(0)
    s_barrier
    ds_read_b64_tr_b16 v[68:69], v125 offset:4608
    ds_read_b64_tr_b16 v[70:71], v125 offset:5184
    ds_read_b64_tr_b16 v[72:73], v125 offset:4640
    ds_read_b64_tr_b16 v[74:75], v125 offset:5216
    ds_read_b64_tr_b16 v[76:77], v125 offset:4672
    ds_read_b64_tr_b16 v[78:79], v125 offset:5248
    ds_read_b64_tr_b16 v[80:81], v125 offset:4704
    ds_read_b64_tr_b16 v[82:83], v125 offset:5280
    ds_read_b64_tr_b16 v[84:85], v125 offset:4736
    ds_read_b64_tr_b16 v[86:87], v125 offset:5312
    ds_read_b64_tr_b16 v[106:107], v125 offset:0
    ds_read_b64_tr_b16 v[108:109], v125 offset:576
    ds_read_b64_tr_b16 v[110:111], v125 offset:32
    ds_read_b64_tr_b16 v[112:113], v125 offset:608
    ds_read_b64_tr_b16 v[114:115], v125 offset:64
    ds_read_b64_tr_b16 v[116:117], v125 offset:640
    ds_read_b64_tr_b16 v[118:119], v125 offset:96
    ds_read_b64_tr_b16 v[120:121], v125 offset:672
    ds_read_b64_tr_b16 v[122:123], v125 offset:128
    ds_read_b64_tr_b16 v[124:125], v125 offset:704
    s_barrier
    s_waitcnt lgkmcnt(0)
    s_barrier
    ds_read_b128 v[126:129], v18 offset:44160
    ds_read_b128 v[130:133], v18 offset:44224
    ds_read_b128 v[134:137], v18 offset:44288
    ds_read_b128 v[138:141], v18 offset:44352
    ds_read_b64_tr_b16 v[36:37], v67 offset:0
    ds_read_b64_tr_b16 v[38:39], v67 offset:1024
    ds_read_b64_tr_b16 v[52:53], v67 offset:8
    ds_read_b64_tr_b16 v[54:55], v67 offset:1032
    ds_read_b64_tr_b16 v[40:41], v67 offset:8192
    ds_read_b64_tr_b16 v[42:43], v67 offset:9216
    ds_read_b64_tr_b16 v[56:57], v67 offset:8200
    ds_read_b64_tr_b16 v[58:59], v67 offset:9224
    ds_read_b64_tr_b16 v[44:45], v67 offset:16384
    ds_read_b64_tr_b16 v[46:47], v67 offset:17408
    ds_read_b64_tr_b16 v[60:61], v67 offset:16392
    ds_read_b64_tr_b16 v[62:63], v67 offset:17416
    s_waitcnt lgkmcnt(8)
    v_mfma_f32_16x16x32_bf16 v[146:149], v[36:39], v[126:129], 0
    v_mfma_f32_16x16x32_bf16 v[150:153], v[52:55], v[126:129], 0
    s_waitcnt lgkmcnt(4)
    v_mfma_f32_16x16x32_bf16 v[146:149], v[40:43], v[130:133], v[146:149]
    v_mfma_f32_16x16x32_bf16 v[150:153], v[56:59], v[130:133], v[150:153]
    s_waitcnt lgkmcnt(0)
    v_mfma_f32_16x16x32_bf16 v[146:149], v[44:47], v[134:137], v[146:149]
    v_mfma_f32_16x16x32_bf16 v[150:153], v[60:63], v[134:137], v[150:153]
    s_barrier
    ds_read_b64_tr_b16 v[48:49], v67 offset:24576
    ds_read_b64_tr_b16 v[50:51], v67 offset:25600
    ds_read_b64_tr_b16 v[64:65], v67 offset:24584
    ds_read_b64_tr_b16 v[66:67], v67 offset:25608
    s_waitcnt lgkmcnt(0)
    v_mfma_f32_16x16x32_bf16 v[146:149], v[48:51], v[138:141], v[146:149]
    v_mfma_f32_16x16x32_bf16 v[150:153], v[64:67], v[138:141], v[150:153]
    s_nop 6
    v_cvt_pk_bf16_f32 v146, v146, v147
    v_cvt_pk_bf16_f32 v147, v148, v149
    v_cvt_pk_bf16_f32 v148, v150, v151
    v_cvt_pk_bf16_f32 v149, v152, v153
    s_and_b64 exec, s[96:97], s[90:91]
    buffer_store_dwordx4 v[146:149], v12, s[4:7], s81 offen
    s_and_b64 exec, s[96:97], s[92:93]
    buffer_store_dwordx4 v[146:149], v12, s[4:7], s81 offen sc1
    s_mov_b64 exec, -1
    s_barrier
    buffer_load_dwordx4 v[154:157], v26, s[4:7], s81 offen sc1
    buffer_load_dwordx4 v[158:161], v26, s[4:7], s81 offen offset:1024 sc1
    buffer_load_dwordx2 v[162:163], v27, s[4:7], s81 offen sc1
    v_mov_b32 v4, 44872
    ds_read_b64 v[152:153], v4
    v_or_b32 v5, 8192, v8
    v_and_b32 v8, 0xffffdfff, v8
    s_waitcnt lgkmcnt(0)
    v_cmp_lt_u32 vcc, v153, v152
    s_nop 1
    v_cndmask_b32 v8, v8, v5, vcc
OG23:
    buffer_load_dwordx4 v[154:157], v26, s[4:7], s81 offen sc1
    buffer_load_dwordx4 v[158:161], v26, s[4:7], s81 offen offset:1024 sc1
    buffer_load_dwordx2 v[162:163], v27, s[4:7], s81 offen sc1
    s_sub_u32 s84, s84, 1
    s_cbranch_scc1 L_END
T_Og2_1:
    s_cbranch_execz T_Og2_2
OW24:
    s_waitcnt vmcnt(3)
    v_max3_u32 v6, v154, v155, v156
    v_max3_u32 v7, v157, v158, v159
    v_max3_u32 v6, v6, v160, v161
    v_max3_u32 v7, v7, v162, v163
    v_max_u32 v6, v6, v7
    v_cmp_eq_u32 vcc, -1, v6
    v_mfma_f32_16x16x32_bf16 v[126:129], v[154:157], v[106:109], 0
    v_mfma_f32_16x16x32_bf16 v[126:129], v[158:161], v[68:71], v[126:129]
    s_cbranch_vccnz OG23
    v_mfma_f32_16x16x32_bf16 v[130:133], v[154:157], v[110:113], 0
    v_max_f32_dpp v4, v162, v162 quad_perm:[1,0,3,2] row_mask:0xf bank_mask:0xf
    v_mfma_f32_16x16x32_bf16 v[130:133], v[158:161], v[72:75], v[130:133]
    v_mfma_f32_16x16x32_bf16 v[134:137], v[154:157], v[114:117], 0
    v_max_f32_dpp v4, v4, v4 quad_perm:[2,3,0,1] row_mask:0xf bank_mask:0xf
    v_mov_b32 v5, v4
    v_mfma_f32_16x16x32_bf16 v[134:137], v[158:161], v[76:79], v[134:137]
    s_nop 0
    v_permlane16_swap_b32 v4, v5
    v_max_f32 v4, v4, v5
    v_mfma_f32_16x16x32_bf16 v[138:141], v[154:157], v[118:121], 0
    v_sub_f32 v151, v162, v4
    v_exp_f32 v151, v151
    v_mfma_f32_16x16x32_bf16 v[138:141], v[158:161], v[80:83], v[138:141]
    v_mul_f32 v4, v151, v163
    v_mfma_f32_16x16x32_bf16 v[142:145], v[154:157], v[122:125], 0
    v_mul_f32_dpp v146, v151, v126 quad_perm:[0,0,0,0] row_mask:0xf bank_mask:0xf
    v_add_f32_dpp v4, v4, v4 quad_perm:[1,0,3,2] row_mask:0xf bank_mask:0xf
    v_mfma_f32_16x16x32_bf16 v[142:145], v[158:161], v[84:87], v[142:145]
    v_mul_f32_dpp v147, v151, v130 quad_perm:[0,0,0,0] row_mask:0xf bank_mask:0xf
    v_add_f32_dpp v4, v4, v4 quad_perm:[2,3,0,1] row_mask:0xf bank_mask:0xf
    v_mov_b32 v5, v4
    v_mul_f32_dpp v148, v151, v134 quad_perm:[0,0,0,0] row_mask:0xf bank_mask:0xf
    v_fmac_f32_dpp v146, v151, v127 quad_perm:[1,1,1,1] row_mask:0xf bank_mask:0xf
    v_permlane16_swap_b32 v4, v5
    v_add_f32 v4, v4, v5
    v_rcp_f32 v4, v4
    v_fmac_f32_dpp v147, v151, v131 quad_perm:[1,1,1,1] row_mask:0xf bank_mask:0xf
    v_fmac_f32_dpp v148, v151, v135 quad_perm:[1,1,1,1] row_mask:0xf bank_mask:0xf
    v_fmac_f32_dpp v146, v151, v128 quad_perm:[2,2,2,2] row_mask:0xf bank_mask:0xf
    v_mul_f32_dpp v149, v151, v138 quad_perm:[0,0,0,0] row_mask:0xf bank_mask:0xf
    v_mul_f32_dpp v150, v151, v142 quad_perm:[0,0,0,0] row_mask:0xf bank_mask:0xf
    v_fmac_f32_dpp v147, v151, v132 quad_perm:[2,2,2,2] row_mask:0xf bank_mask:0xf
    v_fmac_f32_dpp v146, v151, v129 quad_perm:[3,3,3,3] row_mask:0xf bank_mask:0xf
    v_fmac_f32_dpp v148, v151, v136 quad_perm:[2,2,2,2] row_mask:0xf bank_mask:0xf
    v_fmac_f32_dpp v149, v151, v139 quad_perm:[1,1,1,1] row_mask:0xf bank_mask:0xf
    v_mul_f32 v146, v146, v4
    v_fmac_f32_dpp v147, v151, v133 quad_perm:[3,3,3,3] row_mask:0xf bank_mask:0xf
    ds_write_b32 v22, v146 offset:0
    v_fmac_f32_dpp v150, v151, v143 quad_perm:[1,1,1,1] row_mask:0xf bank_mask:0xf
    v_fmac_f32_dpp v148, v151, v137 quad_perm:[3,3,3,3] row_mask:0xf bank_mask:0xf
    v_mul_f32 v147, v147, v4
    v_fmac_f32_dpp v149, v151, v140 quad_perm:[2,2,2,2] row_mask:0xf bank_mask:0xf
    ds_write_b32 v22, v147 offset:768
    v_fmac_f32_dpp v150, v151, v144 quad_perm:[2,2,2,2] row_mask:0xf bank_mask:0xf
    v_mul_f32 v148, v148, v4
    v_fmac_f32_dpp v149, v151, v141 quad_perm:[3,3,3,3] row_mask:0xf bank_mask:0xf
    ds_write_b32 v22, v148 offset:1536
    v_fmac_f32_dpp v150, v151, v145 quad_perm:[3,3,3,3] row_mask:0xf bank_mask:0xf
    v_mul_f32 v149, v149, v4
    ds_write_b32 v22, v149 offset:2304
    v_mul_f32 v150, v150, v4
    ds_write_b32 v22, v150 offset:3072
    s_waitcnt lgkmcnt(0)
    s_barrier
    v_mov_b32 v142, 0
    v_mov_b32 v143, 0
    v_mov_b32 v4, 44872
    ds_read_b64 v[152:153], v4
    v_or_b32 v5, 8192, v8
    v_and_b32 v8, 0xffffdfff, v8
    s_waitcnt lgkmcnt(0)
    v_cmp_lt_u32 vcc, v153, v152
    s_nop 1
    v_cndmask_b32 v8, v8, v5, vcc
    s_barrier
    s_mov_b32 s83, 1048576
    s_mov_b64 vcc, -1
XG25:
    s_mov_b64 exec, vcc
    buffer_load_dwordx4 v[154:157], v8, s[4:7], s83 offen sc1
    s_mov_b64 exec, -1
    s_sub_u32 s84, s84, 1
    s_cbranch_scc1 L_END
T_Og2_2:
    s_cbranch_execz T_Og2_3
    s_waitcnt vmcnt(0)
XW26:
    v_mfma_f32_16x16x32_bf16 v[146:149], v[154:157], v[164:167], 0
    v_max3_u32 v4, v154, v155, v156
    v_max_u32 v4, v4, v157
    v_cmp_eq_u32 vcc, -1, v4
    s_nop 1
    s_cbranch_vccnz XG25
    s_nop 1
    v_permlane32_swap_b32 v146, v147
    v_permlane32_swap_b32 v148, v149
    v_add_f32 v146, v146, v147
    v_add_f32 v148, v148, v149
    s_nop 1
    v_permlane16_swap_b32 v146, v148
    v_add_f32 v146, v146, v32
    v_add_f32 v146, v146, v148
    v_cvt_pk_bf16_f32 v146, v146, v146
    ds_write_b16 v9, v146 offset:42496
    v_lshlrev_b32 v32, 16, v146
    v_add_f32 v32, v32, v33
    s_waitcnt lgkmcnt(0)
    s_barrier
    s_cmp_lg_u32 s79, 0
    s_cbranch_scc1 GS27
    ds_read_b128 v[126:129], v10 offset:42496
    ds_read_b128 v[130:133], v10 offset:42560
    ds_read_b128 v[134:137], v10 offset:42624
    ds_read_b128 v[138:141], v10 offset:42688
    ds_read_b64 v[144:145], v11 offset:42752
    v_cmp_eq_u32 vcc, 1, v1
    s_waitcnt lgkmcnt(4)
    v_mfma_f32_16x16x32_bf16 v[146:149], v[126:129], v[126:129], 0
    s_waitcnt lgkmcnt(3)
    v_mfma_f32_16x16x32_bf16 v[146:149], v[130:133], v[130:133], v[146:149]
    s_waitcnt lgkmcnt(2)
    v_mfma_f32_16x16x32_bf16 v[146:149], v[134:137], v[134:137], v[146:149]
    s_waitcnt lgkmcnt(1)
    v_mfma_f32_16x16x32_bf16 v[146:149], v[138:141], v[138:141], v[146:149]
    s_waitcnt lgkmcnt(0)
    v_mfma_f32_16x16x32_bf16 v[146:149], v[142:145], v[142:145], v[146:149]
    s_nop 7
    v_cndmask_b32 v149, v146, v147, vcc
    s_and_b64 exec, 3, s[90:91]
    buffer_store_dwordx2 v[148:149], v14, s[4:7], s81 offen offset:256
    s_and_b64 exec, 3, s[92:93]
    buffer_store_dwordx2 v[148:149], v14, s[4:7], s81 offen offset:256 sc1
    s_mov_b64 exec, -1
GS27:
    s_barrier
    v_mov_b32 v144, 0
    v_mov_b32 v145, 0
    s_mov_b32 s83, 1179648
    s_mov_b64 exec, 1
HW28:
    buffer_load_dword v4, off, s[4:7], s80 offset:1024 sc1
    s_sub_u32 s84, s84, 1
    s_cbranch_scc1 L_END
T_Og2_3:
    s_cbranch_execz T_Og2_4
    s_waitcnt vmcnt(0)
    v_cmp_eq_u32 vcc, -1, v4
    s_cbranch_vccnz HW28
    s_mov_b64 exec, -1
    v_mov_b32 v4, 44872
    ds_read_b64 v[152:153], v4
    v_or_b32 v5, 8192, v8
    v_and_b32 v8, 0xffffdfff, v8
    s_waitcnt lgkmcnt(0)
    v_cmp_lt_u32 vcc, v153, v152
    s_nop 1
    v_cndmask_b32 v8, v8, v5, vcc
    s_add_u32 s80, s80, 63488
    s_mov_b64 vcc, -1
XG29:
    s_mov_b64 exec, vcc
    buffer_load_dwordx4 v[154:157], v8, s[4:7], s83 offen sc1
    s_mov_b64 exec, -1
    s_sub_u32 s84, s84, 1
    s_cbranch_scc1 L_END
T_Og2_4:
    s_cbranch_execz T_Og2_5
    s_waitcnt vmcnt(0)
XW30:
    v_mfma_f32_16x16x32_bf16 v[146:149], v[154:157], v[164:167], 0
    v_max3_u32 v4, v154, v155, v156
    v_max_u32 v4, v4, v157
    v_cmp_eq_u32 vcc, -1, v4
    s_nop 1
    s_cbranch_vccnz XG29
    s_nop 1
    v_permlane32_swap_b32 v146, v147
    v_permlane32_swap_b32 v148, v149
    v_add_f32 v146, v146, v147
    v_add_f32 v148, v148, v149
    s_nop 1
    v_permlane16_swap_b32 v146, v148
    v_add_f32 v146, v146, v32
    v_add_f32 v146, v146, v148
    v_cvt_pk_bf16_f32 v146, v146, v146
    ds_write_b16 v9, v146 offset:42496
    v_lshlrev_b32 v32, 16, v146
    s_waitcnt lgkmcnt(0)
    s_barrier
    s_cmp_lg_u32 s79, 0
    s_cbranch_scc1 GS31
    ds_read_b128 v[126:129], v10 offset:42496
    ds_read_b128 v[130:133], v10 offset:42560
    ds_read_b128 v[134:137], v10 offset:42624
    ds_read_b128 v[138:141], v10 offset:42688
    ds_read_b64 v[142:143], v11 offset:42752
    v_cmp_eq_u32 vcc, 1, v1
    s_waitcnt lgkmcnt(4)
    v_mfma_f32_16x16x32_bf16 v[146:149], v[126:129], v[126:129], 0
    s_waitcnt lgkmcnt(3)
    v_mfma_f32_16x16x32_bf16 v[146:149], v[130:133], v[130:133], v[146:149]
    s_waitcnt lgkmcnt(2)
    v_mfma_f32_16x16x32_bf16 v[146:149], v[134:137], v[134:137], v[146:149]
    s_waitcnt lgkmcnt(1)
    v_mfma_f32_16x16x32_bf16 v[146:149], v[138:141], v[138:141], v[146:149]
    s_waitcnt lgkmcnt(0)
    v_mfma_f32_16x16x32_bf16 v[146:149], v[142:145], v[142:145], v[146:149]
    s_nop 7
    v_cndmask_b32 v149, v146, v147, vcc
    s_and_b64 exec, 3, s[90:91]
    buffer_store_dwordx2 v[148:149], v14, s[4:7], s82 offen
    s_and_b64 exec, 3, s[92:93]
    buffer_store_dwordx2 v[148:149], v14, s[4:7], s82 offen sc1
    s_mov_b64 exec, -1
GS31:
    s_barrier
    s_waitcnt lgkmcnt(0)
    s_barrier
    s_barrier
    s_barrier
    ds_read_b128 v[126:129], v18 offset:44160
    ds_read_b128 v[130:133], v18 offset:44224
    ds_read_b128 v[134:137], v18 offset:44288
    ds_read_b128 v[138:141], v18 offset:44352
    s_waitcnt lgkmcnt(3)
    v_mfma_f32_16x16x32_bf16 v[146:149], v[36:39], v[126:129], 0
    v_mfma_f32_16x16x32_bf16 v[150:153], v[52:55], v[126:129], 0
    s_waitcnt lgkmcnt(2)
    v_mfma_f32_16x16x32_bf16 v[146:149], v[40:43], v[130:133], v[146:149]
    v_mfma_f32_16x16x32_bf16 v[150:153], v[56:59], v[130:133], v[150:153]
    s_waitcnt lgkmcnt(1)
    v_mfma_f32_16x16x32_bf16 v[146:149], v[44:47], v[134:137], v[146:149]
    v_mfma_f32_16x16x32_bf16 v[150:153], v[60:63], v[134:137], v[150:153]
    s_waitcnt lgkmcnt(0)
    v_mfma_f32_16x16x32_bf16 v[146:149], v[48:51], v[138:141], v[146:149]
    v_mfma_f32_16x16x32_bf16 v[150:153], v[64:67], v[138:141], v[150:153]
    s_nop 6
    v_cvt_pk_bf16_f32 v146, v146, v147
    v_cvt_pk_bf16_f32 v147, v148, v149
    v_cvt_pk_bf16_f32 v148, v150, v151
    v_cvt_pk_bf16_f32 v149, v152, v153
    s_and_b64 exec, s[96:97], s[90:91]
    buffer_store_dwordx4 v[146:149], v12, s[4:7], s82 offen
    s_and_b64 exec, s[96:97], s[92:93]
    buffer_store_dwordx4 v[146:149], v12, s[4:7], s82 offen sc1
    s_mov_b64 exec, -1
    s_barrier
    buffer_load_dwordx4 v[154:157], v26, s[4:7], s82 offen sc1
    buffer_load_dwordx4 v[158:161], v26, s[4:7], s82 offen offset:1024 sc1
    buffer_load_dwordx2 v[162:163], v27, s[4:7], s82 offen sc1
    v_mov_b32 v4, 44872
    ds_read_b64 v[152:153], v4
    v_or_b32 v5, 8192, v8
    v_and_b32 v8, 0xffffdfff, v8
    s_waitcnt lgkmcnt(0)
    v_cmp_lt_u32 vcc, v153, v152
    s_nop 1
    v_cndmask_b32 v8, v8, v5, vcc
OG32:
    buffer_load_dwordx4 v[154:157], v26, s[4:7], s82 offen sc1
    buffer_load_dwordx4 v[158:161], v26, s[4:7], s82 offen offset:1024 sc1
    buffer_load_dwordx2 v[162:163], v27, s[4:7], s82 offen sc1
    s_sub_u32 s84, s84, 1
    s_cbranch_scc1 L_END
T_Og2_5:
    s_cbranch_execz T_Og2_6
OW33:
    s_waitcnt vmcnt(3)
    v_max3_u32 v6, v154, v155, v156
    v_max3_u32 v7, v157, v158, v159
    v_max3_u32 v6, v6, v160, v161
    v_max3_u32 v7, v7, v162, v163
    v_max_u32 v6, v6, v7
    v_cmp_eq_u32 vcc, -1, v6
    v_mfma_f32_16x16x32_bf16 v[126:129], v[154:157], v[106:109], 0
    v_mfma_f32_16x16x32_bf16 v[126:129], v[158:161], v[68:71], v[126:129]
    s_cbranch_vccnz OG32
    v_mfma_f32_16x16x32_bf16 v[130:133], v[154:157], v[110:113], 0
    v_max_f32_dpp v4, v162, v162 quad_perm:[1,0,3,2] row_mask:0xf bank_mask:0xf
    v_mfma_f32_16x16x32_bf16 v[130:133], v[158:161], v[72:75], v[130:133]
    v_mfma_f32_16x16x32_bf16 v[134:137], v[154:157], v[114:117], 0
    v_max_f32_dpp v4, v4, v4 quad_perm:[2,3,0,1] row_mask:0xf bank_mask:0xf
    v_mov_b32 v5, v4
    v_mfma_f32_16x16x32_bf16 v[134:137], v[158:161], v[76:79], v[134:137]
    s_nop 0
    v_permlane16_swap_b32 v4, v5
    v_max_f32 v4, v4, v5
    v_mfma_f32_16x16x32_bf16 v[138:141], v[154:157], v[118:121], 0
    v_sub_f32 v151, v162, v4
    v_exp_f32 v151, v151
    v_mfma_f32_16x16x32_bf16 v[138:141], v[158:161], v[80:83], v[138:141]
    v_mul_f32 v4, v151, v163
    v_mfma_f32_16x16x32_bf16 v[142:145], v[154:157], v[122:125], 0
    v_mul_f32_dpp v146, v151, v126 quad_perm:[0,0,0,0] row_mask:0xf bank_mask:0xf
    v_add_f32_dpp v4, v4, v4 quad_perm:[1,0,3,2] row_mask:0xf bank_mask:0xf
    v_mfma_f32_16x16x32_bf16 v[142:145], v[158:161], v[84:87], v[142:145]
    v_mul_f32_dpp v147, v151, v130 quad_perm:[0,0,0,0] row_mask:0xf bank_mask:0xf
    v_add_f32_dpp v4, v4, v4 quad_perm:[2,3,0,1] row_mask:0xf bank_mask:0xf
    v_mov_b32 v5, v4
    v_mul_f32_dpp v148, v151, v134 quad_perm:[0,0,0,0] row_mask:0xf bank_mask:0xf
    v_fmac_f32_dpp v146, v151, v127 quad_perm:[1,1,1,1] row_mask:0xf bank_mask:0xf
    v_permlane16_swap_b32 v4, v5
    v_add_f32 v4, v4, v5
    v_rcp_f32 v4, v4
    v_fmac_f32_dpp v147, v151, v131 quad_perm:[1,1,1,1] row_mask:0xf bank_mask:0xf
    v_fmac_f32_dpp v148, v151, v135 quad_perm:[1,1,1,1] row_mask:0xf bank_mask:0xf
    v_fmac_f32_dpp v146, v151, v128 quad_perm:[2,2,2,2] row_mask:0xf bank_mask:0xf
    v_mul_f32_dpp v149, v151, v138 quad_perm:[0,0,0,0] row_mask:0xf bank_mask:0xf
    v_mul_f32_dpp v150, v151, v142 quad_perm:[0,0,0,0] row_mask:0xf bank_mask:0xf
    v_fmac_f32_dpp v147, v151, v132 quad_perm:[2,2,2,2] row_mask:0xf bank_mask:0xf
    v_fmac_f32_dpp v146, v151, v129 quad_perm:[3,3,3,3] row_mask:0xf bank_mask:0xf
    v_fmac_f32_dpp v148, v151, v136 quad_perm:[2,2,2,2] row_mask:0xf bank_mask:0xf
    v_fmac_f32_dpp v149, v151, v139 quad_perm:[1,1,1,1] row_mask:0xf bank_mask:0xf
    v_mul_f32 v146, v146, v4
    v_fmac_f32_dpp v147, v151, v133 quad_perm:[3,3,3,3] row_mask:0xf bank_mask:0xf
    ds_write_b32 v22, v146 offset:0
    v_fmac_f32_dpp v150, v151, v143 quad_perm:[1,1,1,1] row_mask:0xf bank_mask:0xf
    v_fmac_f32_dpp v148, v151, v137 quad_perm:[3,3,3,3] row_mask:0xf bank_mask:0xf
    v_mul_f32 v147, v147, v4
    v_fmac_f32_dpp v149, v151, v140 quad_perm:[2,2,2,2] row_mask:0xf bank_mask:0xf
    ds_write_b32 v22, v147 offset:768
    v_fmac_f32_dpp v150, v151, v144 quad_perm:[2,2,2,2] row_mask:0xf bank_mask:0xf
    v_mul_f32 v148, v148, v4
    v_fmac_f32_dpp v149, v151, v141 quad_perm:[3,3,3,3] row_mask:0xf bank_mask:0xf
    ds_write_b32 v22, v148 offset:1536
    v_fmac_f32_dpp v150, v151, v145 quad_perm:[3,3,3,3] row_mask:0xf bank_mask:0xf
    v_mul_f32 v149, v149, v4
    ds_write_b32 v22, v149 offset:2304
    v_mul_f32 v150, v150, v4
    ds_write_b32 v22, v150 offset:3072
    s_waitcnt lgkmcnt(0)
    s_barrier
    s_barrier
    v_mov_b32 v142, 0
    v_mov_b32 v143, 0
    s_mov_b32 s83, 1310720
    s_barrier
    s_mov_b64 vcc, -1
XG34:
    s_mov_b64 exec, vcc
    buffer_load_dwordx4 v[154:157], v8, s[4:7], s83 offen sc1
    s_mov_b64 exec, -1
    s_sub_u32 s84, s84, 1
    s_cbranch_scc1 L_END
T_Og2_6:
    s_cbranch_execz T_Og2_7
    s_waitcnt vmcnt(0)
XW35:
    v_mfma_f32_16x16x32_bf16 v[146:149], v[154:157], v[164:167], 0
    v_max3_u32 v4, v154, v155, v156
    v_max_u32 v4, v4, v157
    v_cmp_eq_u32 vcc, -1, v4
    s_nop 1
    s_cbranch_vccnz XG34
    s_nop 1
    v_permlane32_swap_b32 v146, v147
    v_permlane32_swap_b32 v148, v149
    v_add_f32 v146, v146, v147
    v_add_f32 v148, v148, v149
    s_nop 1
    v_permlane16_swap_b32 v146, v148
    v_add_f32 v146, v146, v32
    v_add_f32 v146, v146, v148
    v_cvt_pk_bf16_f32 v146, v146, v146
    ds_write_b16 v9, v146 offset:42496
    v_lshlrev_b32 v32, 16, v146
    v_add_f32 v32, v32, v33
    s_waitcnt lgkmcnt(0)
    s_barrier
    s_cmp_lg_u32 s79, 0
    s_cbranch_scc1 GS36
    ds_read_b128 v[126:129], v10 offset:42496
    ds_read_b128 v[130:133], v10 offset:42560
    ds_read_b128 v[134:137], v10 offset:42624
    ds_read_b128 v[138:141], v10 offset:42688
    ds_read_b64 v[144:145], v11 offset:42752
    v_cmp_eq_u32 vcc, 1, v1
    s_waitcnt lgkmcnt(4)
    v_mfma_f32_16x16x32_bf16 v[146:149], v[126:129], v[126:129], 0
    s_waitcnt lgkmcnt(3)
    v_mfma_f32_16x16x32_bf16 v[146:149], v[130:133], v[130:133], v[146:149]
    s_waitcnt lgkmcnt(2)
    v_mfma_f32_16x16x32_bf16 v[146:149], v[134:137], v[134:137], v[146:149]
    s_waitcnt lgkmcnt(1)
    v_mfma_f32_16x16x32_bf16 v[146:149], v[138:141], v[138:141], v[146:149]
    s_waitcnt lgkmcnt(0)
    v_mfma_f32_16x16x32_bf16 v[146:149], v[142:145], v[142:145], v[146:149]
    s_nop 7
    v_cndmask_b32 v149, v146, v147, vcc
    s_and_b64 exec, 3, s[90:91]
    buffer_store_dwordx2 v[148:149], v14, s[4:7], s82 offen offset:256
    s_and_b64 exec, 3, s[92:93]
    buffer_store_dwordx2 v[148:149], v14, s[4:7], s82 offen offset:256 sc1
    s_mov_b64 exec, -1
GS36:
    s_barrier
    s_and_b32 s85, s2, 63
    s_cbranch_scc0 GO37
    s_endpgm
GO37:
    v_and_b32 v4, 1, v1
    v_mul_u32_u24 v4, 832, v4
    s_mul_i32 s85, s78, 288
    v_add3_u32 v9, v9, v4, s85
    s_mov_b32 s83, 1441792
    s_mov_b64 exec, 1
HW38:
    buffer_load_dword v4, off, s[4:7], s80 offset:1024 sc1
    s_sub_u32 s84, s84, 1
    s_cbranch_scc1 L_END
T_Og2_7:
    s_cbranch_execz T_Og2_8
    s_waitcnt vmcnt(0)
    v_cmp_eq_u32 vcc, -1, v4
    s_cbranch_vccnz HW38
    s_mov_b64 exec, -1
    v_mov_b32 v4, 44872
    ds_read_b64 v[152:153], v4
    v_or_b32 v5, 8192, v8
    v_and_b32 v8, 0xffffdfff, v8
    s_waitcnt lgkmcnt(0)
    v_cmp_lt_u32 vcc, v153, v152
    s_nop 1
    v_cndmask_b32 v8, v8, v5, vcc
    s_mov_b64 vcc, -1
XG39:
    s_mov_b64 exec, vcc
    buffer_load_dwordx4 v[154:157], v8, s[4:7], s83 offen sc1
    s_mov_b64 exec, -1
    s_sub_u32 s84, s84, 1
    s_cbranch_scc1 L_END
T_Og2_8:
    s_cbranch_execz T_Og2_9
    s_waitcnt vmcnt(0)
XW40:
    v_mfma_f32_16x16x32_bf16 v[146:149], v[154:157], v[164:167], 0
    v_max3_u32 v4, v154, v155, v156
    v_max_u32 v4, v4, v157
    v_cmp_eq_u32 vcc, -1, v4
    s_nop 1
    s_cbranch_vccnz XG39
    s_nop 1
    v_permlane32_swap_b32 v146, v147
    v_permlane32_swap_b32 v148, v149
    v_add_f32 v146, v146, v147
    v_add_f32 v148, v148, v149
    s_nop 1
    v_permlane16_swap_b32 v146, v148
    v_add_f32 v146, v146, v32
    v_add_f32 v146, v146, v148
    v_cvt_pk_bf16_f32 v146, v146, v146
    buffer_store_short v146, v9, s[8:11], 0 offen
    s_endpgm
T_Og2_9:
    s_branch U_Og2
    .p2align 12
T_Oax:
    s_branch T_Oax_1
B_Oax:
    s_waitcnt lgkmcnt(0)
    s_barrier
    s_barrier
    ds_read_b128 v[142:145], v20 offset:44800
    s_waitcnt lgkmcnt(0)
    v_max3_f32 v4, v142, v143, v144
    v_max_f32 v150, v4, v145
    s_barrier
    ds_read_b64 v[146:147], v14 offset:44160
    s_waitcnt lgkmcnt(0)
    v_lshlrev_b32 v148, 16, v146
    v_and_b32 v146, 0xffff0000, v146
    v_lshlrev_b32 v149, 16, v147
    v_and_b32 v147, 0xffff0000, v147
    v_pk_add_f32 v[146:147], v[146:147], v[148:149]
    v_add_f32 v151, v146, v147
    s_nop 1
    v_add_f32_dpp v151, v151, v151 row_ror:8 row_mask:0xf bank_mask:0xf
    s_nop 1
    v_add_f32_dpp v151, v151, v151 row_ror:4 row_mask:0xf bank_mask:0xf
    s_nop 1
    v_add_f32_dpp v151, v151, v151 row_ror:2 row_mask:0xf bank_mask:0xf
    s_nop 1
    v_add_f32_dpp v151, v151, v151 row_ror:1 row_mask:0xf bank_mask:0xf
    v_mov_b32 v4, v151
    s_nop 1
    v_permlane16_swap_b32 v151, v4
    v_add_f32 v151, v151, v4
    s_and_b64 exec, s[98:99], s[90:91]
    buffer_store_dwordx2 v[150:151], v12, s[4:7], s81 offen
    s_and_b64 exec, s[98:99], s[92:93]
    buffer_store_dwordx2 v[150:151], v12, s[4:7], s81 offen sc1
    s_mov_b64 exec, -1
    s_load_dwordx8 s[24:31], s[46:47], 128
    s_barrier
    s_barrier
    v_and_b32 v5, 28, v42
    s_waitcnt lgkmcnt(0)
    s_and_b64 s[24:25], s[24:25], s[26:27]
    s_and_b64 s[28:29], s[28:29], s[30:31]
    s_and_b64 s[24:25], s[24:25], s[28:29]
    s_cmp_eq_u64 s[24:25], -1
    s_cbranch_scc1 FK48
FG47:
    buffer_load_dword v4, v5, s[12:15], 0 offen offset:128 sc1
    s_sub_u32 s84, s84, 1
    s_cbranch_scc1 L_END
T_Oax_1:
    s_cbranch_execz T_Oax_2
    s_waitcnt vmcnt(0)
    v_cmp_ne_u32 vcc, -1, v4
    s_cbranch_vccnz FG47
FK48:
    s_waitcnt lgkmcnt(0)
    s_barrier
    s_mul_i32 s85, s77, 1792
    s_add_u32 s85, s85, s81
    s_add_u32 s85, s85, 71680
    s_and_b64 exec, -1, s[90:91]
    buffer_store_dwordx4 v[36:39], v40, s[4:7], s85 offen offset:0
    s_and_b64 exec, -1, s[92:93]
    buffer_store_dwordx4 v[36:39], v40, s[4:7], s85 offen offset:0 sc1
    s_mov_b64 exec, -1
    s_and_b64 exec, -1, s[90:91]
    buffer_store_dwordx4 v[36:39], v40, s[4:7], s85 offen offset:768
    s_and_b64 exec, -1, s[92:93]
    buffer_store_dwordx4 v[36:39], v40, s[4:7], s85 offen offset:768 sc1
    s_mov_b64 exec, -1
    v_mov_b32 v142, 0
    v_mov_b32 v143, 0
    v_mov_b32 v4, 44872
    ds_read_b64 v[152:153], v4
    v_or_b32 v5, 8192, v8
    v_and_b32 v8, 0xffffdfff, v8
    s_waitcnt lgkmcnt(0)
    v_cmp_lt_u32 vcc, v153, v152
    s_nop 1
    v_cndmask_b32 v8, v8, v5, vcc
    ds_read_b64_tr_b16 v[88:89], v89 offset:39680
    ds_read_b64_tr_b16 v[90:91], v105 offset:21248
    ds_read_b64_tr_b16 v[92:93], v105 offset:21824
    ds_read_b64_tr_b16 v[94:95], v105 offset:25856
    ds_read_b64_tr_b16 v[96:97], v105 offset:26432
    ds_read_b64_tr_b16 v[98:99], v105 offset:30464
    ds_read_b64_tr_b16 v[100:101], v105 offset:31040
    ds_read_b64_tr_b16 v[102:103], v105 offset:35072
    ds_read_b64_tr_b16 v[104:105], v105 offset:35648
    ds_read_b128 v[126:129], v10 offset:42496
    ds_read_b128 v[130:133], v10 offset:42560
    ds_read_b128 v[134:137], v10 offset:42624
    ds_read_b128 v[138:141], v10 offset:42688
    ds_read_b64 v[144:145], v11 offset:42752
    s_waitcnt lgkmcnt(4)
    v_mfma_f32_16x16x32_bf16 v[146:149], v[90:93], v[126:129], 0
    s_waitcnt lgkmcnt(3)
    v_mfma_f32_16x16x32_bf16 v[146:149], v[94:97], v[130:133], v[146:149]
    s_waitcnt lgkmcnt(2)
    v_mfma_f32_16x16x32_bf16 v[146:149], v[98:101], v[134:137], v[146:149]
    s_waitcnt lgkmcnt(1)
    v_mfma_f32_16x16x32_bf16 v[146:149], v[102:105], v[138:141], v[146:149]
    s_waitcnt lgkmcnt(0)
    v_mfma_f32_16x16x32_bf16 v[146:149], v[86:89], v[142:145], v[146:149]
    s_andn2_b64 s[94:95], s[94:95], s[96:97]
    s_and_b64 exec, s[94:95], s[90:91]
    s_nop 5
    buffer_store_dwordx4 v[146:149], v13, s[4:7], s81 offen
    s_and_b64 exec, s[94:95], s[92:93]
    buffer_store_dwordx4 v[146:149], v13, s[4:7], s81 offen sc1
    s_mov_b64 exec, -1
    s_barrier
    s_mov_b32 s83, 1048576
    s_mov_b64 vcc, -1
XG49:
    s_mov_b64 exec, vcc
    buffer_load_dwordx4 v[154:157], v8, s[4:7], s83 offen sc1
    s_mov_b64 exec, -1
    s_sub_u32 s84, s84, 1
    s_cbranch_scc1 L_END
T_Oax_2:
    s_cbranch_execz T_Oax_3
    s_waitcnt vmcnt(0)
XW50:
    v_mfma_f32_16x16x32_bf16 v[146:149], v[154:157], v[164:167], 0
    v_max3_u32 v4, v154, v155, v156
    v_max_u32 v4, v4, v157
    v_cmp_eq_u32 vcc, -1, v4
    s_nop 1
    s_cbranch_vccnz XG49
    s_nop 1
    v_permlane32_swap_b32 v146, v147
    v_permlane32_swap_b32 v148, v149
    v_add_f32 v146, v146, v147
    v_add_f32 v148, v148, v149
    s_nop 1
    v_permlane16_swap_b32 v146, v148
    v_add_f32 v146, v146, v32
    v_add_f32 v146, v146, v148
    v_cvt_pk_bf16_f32 v146, v146, v146
    ds_write_b16 v9, v146 offset:42496
    v_lshlrev_b32 v32, 16, v146
    v_add_f32 v32, v32, v33
    s_waitcnt lgkmcnt(0)
    s_barrier
    ds_read_b128 v[126:129], v10 offset:42496
    ds_read_b128 v[130:133], v10 offset:42560
    ds_read_b128 v[134:137], v10 offset:42624
    ds_read_b128 v[138:141], v10 offset:42688
    ds_read_b64 v[144:145], v11 offset:42752
    s_waitcnt lgkmcnt(4)
    v_mfma_f32_16x16x32_bf16 v[146:149], v[90:93], v[126:129], 0
    s_waitcnt lgkmcnt(3)
    v_mfma_f32_16x16x32_bf16 v[146:149], v[94:97], v[130:133], v[146:149]
    s_waitcnt lgkmcnt(2)
    v_mfma_f32_16x16x32_bf16 v[146:149], v[98:101], v[134:137], v[146:149]
    s_waitcnt lgkmcnt(1)
    v_mfma_f32_16x16x32_bf16 v[146:149], v[102:105], v[138:141], v[146:149]
    s_waitcnt lgkmcnt(0)
    v_mfma_f32_16x16x32_bf16 v[146:149], v[86:89], v[142:145], v[146:149]
    s_and_b64 exec, s[96:97], s[90:91]
    s_nop 6
    buffer_store_dwordx4 v[146:149], v13, s[4:7], s81 offen
    s_and_b64 exec, s[96:97], s[92:93]
    buffer_store_dwordx4 v[146:149], v13, s[4:7], s81 offen sc1
    s_mov_b64 exec, -1
    s_barrier
    s_mul_i32 s85, s77, 3584
    s_add_u32 s85, s85, s81
    s_add_u32 s85, s85, 71680
    v_lshlrev_b32 v4, 7, v1
    s_mov_b64 exec, 268435455
    buffer_load_dword v41, v4, s[4:7], s85 offen offset:0 sc1
    s_mov_b64 exec, -1
    s_cmp_lg_u32 s2, 0
    s_cbranch_scc1 EP51
    v_mov_b32 v5, s32
    s_mov_b32 s85, 130944
    s_mov_b64 exec, 1
    buffer_store_dword v5, off, s[4:7], s85 sc1
    s_mov_b64 exec, -1
EP51:
    v_mov_b32 v144, 0
    v_mov_b32 v145, 0
    s_mov_b32 s83, 1179648
    s_mov_b64 exec, 1
HW52:
    buffer_load_dword v4, off, s[4:7], s80 offset:1024 sc1
    s_sub_u32 s84, s84, 1
    s_cbranch_scc1 L_END
T_Oax_3:
    s_cbranch_execz T_Oax_4
    s_waitcnt vmcnt(0)
    v_cmp_eq_u32 vcc, -1, v4
    s_cbranch_vccnz HW52
    s_mov_b64 exec, -1
    v_mov_b32 v4, 44872
    ds_read_b64 v[152:153], v4
    v_or_b32 v5, 8192, v8
    v_and_b32 v8, 0xffffdfff, v8
    s_waitcnt lgkmcnt(0)
    v_cmp_lt_u32 vcc, v153, v152
    s_nop 1
    v_cndmask_b32 v8, v8, v5, vcc
    s_add_u32 s80, s80, 63488
    s_mov_b64 vcc, -1
XG53:
    s_mov_b64 exec, vcc
    buffer_load_dwordx4 v[154:157], v8, s[4:7], s83 offen sc1
    s_mov_b64 exec, -1
    s_sub_u32 s84, s84, 1
    s_cbranch_scc1 L_END
T_Oax_4:
    s_cbranch_execz T_Oax_5
    s_waitcnt vmcnt(0)
XW54:
    v_mfma_f32_16x16x32_bf16 v[146:149], v[154:157], v[164:167], 0
    v_max3_u32 v4, v154, v155, v156
    v_max_u32 v4, v4, v157
    v_cmp_eq_u32 vcc, -1, v4
    s_nop 1
    s_cbranch_vccnz XG53
    s_nop 1
    v_permlane32_swap_b32 v146, v147
    v_permlane32_swap_b32 v148, v149
    v_add_f32 v146, v146, v147
    v_add_f32 v148, v148, v149
    s_nop 1
    v_permlane16_swap_b32 v146, v148
    v_add_f32 v146, v146, v32
    v_add_f32 v146, v146, v148
    v_cvt_pk_bf16_f32 v146, v146, v146
    ds_write_b16 v9, v146 offset:42496
    v_lshlrev_b32 v32, 16, v146
    s_waitcnt lgkmcnt(0)
    s_barrier
    s_barrier
    s_waitcnt lgkmcnt(0)
    s_barrier
    s_barrier
    ds_read_b128 v[142:145], v20 offset:44832
    s_waitcnt lgkmcnt(0)
    v_max3_f32 v4, v142, v143, v144
    v_max_f32 v150, v4, v145
    s_barrier
    ds_read_b64 v[146:147], v14 offset:44160
    s_waitcnt lgkmcnt(0)
    v_lshlrev_b32 v148, 16, v146
    v_and_b32 v146, 0xffff0000, v146
    v_lshlrev_b32 v149, 16, v147
    v_and_b32 v147, 0xffff0000, v147
    v_pk_add_f32 v[146:147], v[146:147], v[148:149]
    v_add_f32 v151, v146, v147
    s_nop 1
    v_add_f32_dpp v151, v151, v151 row_ror:8 row_mask:0xf bank_mask:0xf
    s_nop 1
    v_add_f32_dpp v151, v151, v151 row_ror:4 row_mask:0xf bank_mask:0xf
    s_nop 1
    v_add_f32_dpp v151, v151, v151 row_ror:2 row_mask:0xf bank_mask:0xf
    s_nop 1
    v_add_f32_dpp v151, v151, v151 row_ror:1 row_mask:0xf bank_mask:0xf
    v_mov_b32 v4, v151
    s_nop 1
    v_permlane16_swap_b32 v151, v4
    v_add_f32 v151, v151, v4
    s_and_b64 exec, s[98:99], s[90:91]
    buffer_store_dwordx2 v[150:151], v12, s[4:7], s82 offen
    s_and_b64 exec, s[98:99], s[92:93]
    buffer_store_dwordx2 v[150:151], v12, s[4:7], s82 offen sc1
    s_mov_b64 exec, -1
    s_barrier
    s_waitcnt lgkmcnt(0)
    s_barrier
    s_barrier
    v_mov_b32 v142, 0
    v_mov_b32 v143, 0
    s_mov_b32 s83, 1310720
    s_mov_b64 exec, 1
HW55:
    buffer_load_dword v4, off, s[4:7], s80 offset:0 sc1
    s_sub_u32 s84, s84, 1
    s_cbranch_scc1 L_END
T_Oax_5:
    s_cbranch_execz T_Oax_6
    s_waitcnt vmcnt(0)
    v_cmp_eq_u32 vcc, -1, v4
    s_cbranch_vccnz HW55
    s_mov_b64 exec, -1
    s_barrier
    s_mov_b64 vcc, -1
XG56:
    s_mov_b64 exec, vcc
    buffer_load_dwordx4 v[154:157], v8, s[4:7], s83 offen sc1
    s_mov_b64 exec, -1
    s_sub_u32 s84, s84, 1
    s_cbranch_scc1 L_END
T_Oax_6:
    s_cbranch_execz T_Oax_7
    s_waitcnt vmcnt(0)
XW57:
    v_mfma_f32_16x16x32_bf16 v[146:149], v[154:157], v[164:167], 0
    v_max3_u32 v4, v154, v155, v156
    v_max_u32 v4, v4, v157
    v_cmp_eq_u32 vcc, -1, v4
    s_nop 1
    s_cbranch_vccnz XG56
    s_nop 1
    v_permlane32_swap_b32 v146, v147
    v_permlane32_swap_b32 v148, v149
    v_add_f32 v146, v146, v147
    v_add_f32 v148, v148, v149
    s_nop 1
    v_permlane16_swap_b32 v146, v148
    v_add_f32 v146, v146, v32
    v_add_f32 v146, v146, v148
    v_cvt_pk_bf16_f32 v146, v146, v146
    ds_write_b16 v9, v146 offset:42496
    v_lshlrev_b32 v32, 16, v146
    v_add_f32 v32, v32, v33
    s_waitcnt lgkmcnt(0)
    s_barrier
    ds_read_b128 v[126:129], v10 offset:42496
    ds_read_b128 v[130:133], v10 offset:42560
    ds_read_b128 v[134:137], v10 offset:42624
    ds_read_b128 v[138:141], v10 offset:42688
    ds_read_b64 v[144:145], v11 offset:42752
    s_waitcnt lgkmcnt(4)
    v_mfma_f32_16x16x32_bf16 v[146:149], v[90:93], v[126:129], 0
    s_waitcnt lgkmcnt(3)
    v_mfma_f32_16x16x32_bf16 v[146:149], v[94:97], v[130:133], v[146:149]
    s_waitcnt lgkmcnt(2)
    v_mfma_f32_16x16x32_bf16 v[146:149], v[98:101], v[134:137], v[146:149]
    s_waitcnt lgkmcnt(1)
    v_mfma_f32_16x16x32_bf16 v[146:149], v[102:105], v[138:141], v[146:149]
    s_waitcnt lgkmcnt(0)
    v_mfma_f32_16x16x32_bf16 v[146:149], v[86:89], v[142:145], v[146:149]
    s_and_b64 exec, s[96:97], s[90:91]
    s_nop 6
    buffer_store_dwordx4 v[146:149], v13, s[4:7], s82 offen
    s_and_b64 exec, s[96:97], s[92:93]
    buffer_store_dwordx4 v[146:149], v13, s[4:7], s82 offen sc1
    s_mov_b64 exec, -1
    s_barrier
    s_and_b32 s85, s2, 63
    s_cbranch_scc0 GO58
    s_endpgm
GO58:
    v_and_b32 v4, 1, v1
    v_mul_u32_u24 v4, 832, v4
    s_mul_i32 s85, s78, 288
    v_add3_u32 v9, v9, v4, s85
    s_mov_b32 s83, 1441792
    s_mov_b64 exec, 1
HW59:
    buffer_load_dword v4, off, s[4:7], s80 offset:1024 sc1
    s_sub_u32 s84, s84, 1
    s_cbranch_scc1 L_END
T_Oax_7:
    s_cbranch_execz T_Oax_8
    s_waitcnt vmcnt(0)
    v_cmp_eq_u32 vcc, -1, v4
    s_cbranch_vccnz HW59
    s_mov_b64 exec, -1
    v_mov_b32 v4, 44872
    ds_read_b64 v[152:153], v4
    v_or_b32 v5, 8192, v8
    v_and_b32 v8, 0xffffdfff, v8
    s_waitcnt lgkmcnt(0)
    v_cmp_lt_u32 vcc, v153, v152
    s_nop 1
    v_cndmask_b32 v8, v8, v5, vcc
    s_mov_b64 vcc, -1
XG60:
    s_mov_b64 exec, vcc
    buffer_load_dwordx4 v[154:157], v8, s[4:7], s83 offen sc1
    s_mov_b64 exec, -1
    s_sub_u32 s84, s84, 1
    s_cbranch_scc1 L_END
T_Oax_8:
    s_cbranch_execz T_Oax_9
    s_waitcnt vmcnt(0)
XW61:
    v_mfma_f32_16x16x32_bf16 v[146:149], v[154:157], v[164:167], 0
    v_max3_u32 v4, v154, v155, v156
    v_max_u32 v4, v4, v157
    v_cmp_eq_u32 vcc, -1, v4
    s_nop 1
    s_cbranch_vccnz XG60
    s_nop 1
    v_permlane32_swap_b32 v146, v147
    v_permlane32_swap_b32 v148, v149
    v_add_f32 v146, v146, v147
    v_add_f32 v148, v148, v149
    s_nop 1
    v_permlane16_swap_b32 v146, v148
    v_add_f32 v146, v146, v32
    v_add_f32 v146, v146, v148
    v_cvt_pk_bf16_f32 v146, v146, v146
    buffer_store_short v146, v9, s[8:11], 0 offen
    s_endpgm
T_Oax_9:
    s_branch U_Oax
    .p2align 12
T_Mg1:
    s_branch T_Mg1_1
B_Mg1:
    s_waitcnt lgkmcnt(0)
    s_barrier
    ds_read_b128 v[126:129], v18 offset:43520
    ds_read_b128 v[130:133], v18 offset:43584
    ds_read_b128 v[134:137], v18 offset:43648
    ds_read_b128 v[138:141], v18 offset:43712
    s_waitcnt lgkmcnt(3)
    v_mfma_f32_16x16x32_bf16 v[146:149], v[36:39], v[126:129], 0
    v_mfma_f32_16x16x32_bf16 v[150:153], v[52:55], v[126:129], 0
    s_waitcnt lgkmcnt(2)
    v_mfma_f32_16x16x32_bf16 v[146:149], v[40:43], v[130:133], v[146:149]
    v_mfma_f32_16x16x32_bf16 v[150:153], v[56:59], v[130:133], v[150:153]
    s_waitcnt lgkmcnt(1)
    v_mfma_f32_16x16x32_bf16 v[146:149], v[44:47], v[134:137], v[146:149]
    v_mfma_f32_16x16x32_bf16 v[150:153], v[60:63], v[134:137], v[150:153]
    s_waitcnt lgkmcnt(0)
    v_mfma_f32_16x16x32_bf16 v[146:149], v[48:51], v[138:141], v[146:149]
    v_mfma_f32_16x16x32_bf16 v[150:153], v[64:67], v[138:141], v[150:153]
    s_mov_b64 exec, s[96:97]
    s_nop 5
    v_max3_f32 v4, v146, v147, v148
    v_max3_f32 v5, v150, v151, v152
    v_max3_f32 v4, v4, v149, v153
    v_max_f32 v4, v4, v5
    ds_max_f32 v19, v4 offset:44800
    s_mov_b64 exec, -1
    v_cndmask_b32 v146, v146, v150, s[38:39]
    v_cndmask_b32 v147, v147, v151, s[38:39]
    v_cndmask_b32 v148, v148, v152, s[38:39]
    v_cndmask_b32 v149, v149, v153, s[38:39]
    v_cndmask_b32 v146, v146, v148, s[36:37]
    v_cndmask_b32 v147, v147, v149, s[36:37]
    v_cndmask_b32 v146, v146, v147, s[34:35]
    s_waitcnt lgkmcnt(0)
    s_barrier
    ds_read_b128 v[142:145], v20 offset:44800
    s_waitcnt lgkmcnt(0)
    v_max3_f32 v4, v142, v143, v144
    v_max_f32 v4, v4, v145
    v_sub_f32 v146, v146, v4
    v_exp_f32 v146, v146
    s_nop 0
    v_cvt_pk_bf16_f32 v146, v146, v146
    ds_write_b16 v21, v146 offset:44160
    s_waitcnt lgkmcnt(0)
    s_barrier
    s_barrier
    s_barrier
    s_cmp_ge_u32 s75, 4
    s_cbranch_scc1 PK68
    s_andn2_b32 s86, s33, 8192
    s_or_b32 s87, s33, 8192
    v_mov_b32 v4, 0
    s_memtime s[24:25]
    s_load_dword s30, s[72:73], s86 glc
    s_waitcnt lgkmcnt(0)
    s_memtime s[26:27]
    s_load_dword s30, s[72:73], s87 glc
    s_waitcnt lgkmcnt(0)
    s_memtime s[28:29]
    s_sub_u32 s86, s26, s24
    v_mov_b32 v5, s86
    s_waitcnt lgkmcnt(0)
    s_sub_u32 s87, s28, s26
    v_mov_b32 v6, s87
    s_mov_b64 exec, 1
    ds_min_u32 v4, v5 offset:44872
    ds_min_u32 v4, v6 offset:44876
    s_mov_b64 exec, -1
PK68:
    s_waitcnt lgkmcnt(0)
    s_barrier
    v_mov_b32 v142, 0
    v_mov_b32 v143, 0
    v_mov_b32 v4, 44872
    ds_read_b64 v[152:153], v4
    v_or_b32 v5, 8192, v8
    v_and_b32 v8, 0xffffdfff, v8
    s_waitcnt lgkmcnt(0)
    v_cmp_lt_u32 vcc, v153, v152
    s_nop 1
    v_cndmask_b32 v8, v8, v5, vcc
    s_mov_b32 s83, 1048576
    buffer_load_dwordx4 v[154:157], v8, s[4:7], s83 offen sc1
    ds_read_b64_tr_b16 v[88:89], v89 offset:39680
    ds_read_b64_tr_b16 v[90:91], v105 offset:21248
    ds_read_b64_tr_b16 v[92:93], v105 offset:21824
    ds_read_b64_tr_b16 v[94:95], v105 offset:25856
    ds_read_b64_tr_b16 v[96:97], v105 offset:26432
    ds_read_b64_tr_b16 v[98:99], v105 offset:30464
    ds_read_b64_tr_b16 v[100:101], v105 offset:31040
    ds_read_b64_tr_b16 v[102:103], v105 offset:35072
    ds_read_b64_tr_b16 v[104:105], v105 offset:35648
    ds_read_b128 v[126:129], v10 offset:42496
    ds_read_b128 v[130:133], v10 offset:42560
    ds_read_b128 v[134:137], v10 offset:42624
    ds_read_b128 v[138:141], v10 offset:42688
    ds_read_b64 v[144:145], v11 offset:42752
    s_waitcnt lgkmcnt(4)
    v_mfma_f32_16x16x32_bf16 v[146:149], v[90:93], v[126:129], 0
    s_waitcnt lgkmcnt(3)
    v_mfma_f32_16x16x32_bf16 v[146:149], v[94:97], v[130:133], v[146:149]
    s_waitcnt lgkmcnt(2)
    v_mfma_f32_16x16x32_bf16 v[146:149], v[98:101], v[134:137], v[146:149]
    s_waitcnt lgkmcnt(1)
    v_mfma_f32_16x16x32_bf16 v[146:149], v[102:105], v[138:141], v[146:149]
    s_waitcnt lgkmcnt(0)
    v_mfma_f32_16x16x32_bf16 v[146:149], v[86:89], v[142:145], v[146:149]
    s_andn2_b64 s[94:95], s[94:95], s[96:97]
    s_and_b64 exec, s[94:95], s[90:91]
    s_nop 5
    buffer_store_dwordx4 v[146:149], v13, s[4:7], s81 offen
    s_and_b64 exec, s[94:95], s[92:93]
    buffer_store_dwordx4 v[146:149], v13, s[4:7], s81 offen sc1
    s_mov_b64 exec, -1
    ds_read_b64_tr_b16 v[106:107], v125 offset:0
    ds_read_b64_tr_b16 v[108:109], v125 offset:576
    ds_read_b64_tr_b16 v[110:111], v125 offset:32
    ds_read_b64_tr_b16 v[112:113], v125 offset:608
    ds_read_b64_tr_b16 v[114:115], v125 offset:64
    ds_read_b64_tr_b16 v[116:117], v125 offset:640
    ds_read_b64_tr_b16 v[118:119], v125 offset:96
    ds_read_b64_tr_b16 v[120:121], v125 offset:672
    ds_read_b64_tr_b16 v[122:123], v125 offset:128
    ds_read_b64_tr_b16 v[124:125], v125 offset:704
    s_waitcnt vmcnt(0)
    s_branch XW70
XG69:
    s_mov_b64 exec, vcc
    buffer_load_dwordx4 v[154:157], v8, s[4:7], s83 offen sc1
    s_mov_b64 exec, -1
    s_sub_u32 s84, s84, 1
    s_cbranch_scc1 L_END
T_Mg1_1:
    s_cbranch_execz T_Mg1_2
    s_waitcnt vmcnt(0)
XW70:
    v_mfma_f32_16x16x32_bf16 v[146:149], v[154:157], v[164:167], 0
    v_max3_u32 v4, v154, v155, v156
    v_max_u32 v4, v4, v157
    v_cmp_eq_u32 vcc, -1, v4
    s_nop 1
    s_cbranch_vccnz XG69
    s_nop 1
    v_permlane32_swap_b32 v146, v147
    v_permlane32_swap_b32 v148, v149
    v_add_f32 v146, v146, v147
    v_add_f32 v148, v148, v149
    s_nop 1
    v_permlane16_swap_b32 v146, v148
    v_add_f32 v146, v146, v32
    v_add_f32 v146, v146, v148
    v_cvt_pk_bf16_f32 v146, v146, v146
    ds_write_b16 v9, v146 offset:42496
    v_lshlrev_b32 v32, 16, v146
    v_add_f32 v32, v32, v33
    s_add_u32 s85, s81, 4608
    buffer_load_dword v160, v28, s[4:7], s81 offen offset:0 sc1
    buffer_load_dword v161, v28, s[4:7], s81 offen offset:2304 sc1
    buffer_load_dword v162, v28, s[4:7], s85 offen offset:0 sc1
    buffer_load_dword v163, v28, s[4:7], s85 offen offset:2304 sc1
    s_waitcnt lgkmcnt(0)
    s_barrier
    ds_read_b128 v[126:129], v10 offset:42496
    ds_read_b128 v[130:133], v10 offset:42560
    ds_read_b128 v[134:137], v10 offset:42624
    ds_read_b128 v[138:141], v10 offset:42688
    ds_read_b64 v[144:145], v11 offset:42752
    s_waitcnt lgkmcnt(4)
    v_mfma_f32_16x16x32_bf16 v[146:149], v[90:93], v[126:129], 0
    s_waitcnt lgkmcnt(3)
    v_mfma_f32_16x16x32_bf16 v[146:149], v[94:97], v[130:133], v[146:149]
    s_waitcnt lgkmcnt(2)
    v_mfma_f32_16x16x32_bf16 v[146:149], v[98:101], v[134:137], v[146:149]
    s_waitcnt lgkmcnt(1)
    v_mfma_f32_16x16x32_bf16 v[146:149], v[102:105], v[138:141], v[146:149]
    s_waitcnt lgkmcnt(0)
    v_mfma_f32_16x16x32_bf16 v[146:149], v[86:89], v[142:145], v[146:149]
    s_and_b64 exec, s[96:97], s[90:91]
    s_nop 6
    buffer_store_dwordx4 v[146:149], v13, s[4:7], s81 offen
    s_and_b64 exec, s[96:97], s[92:93]
    buffer_store_dwordx4 v[146:149], v13, s[4:7], s81 offen sc1
    s_mov_b64 exec, -1
    v_mov_b32 v7, 0xc0135761
    s_barrier
    buffer_load_dword v154, v26, s[4:7], s81 offen offset:0 sc1
    buffer_load_dword v155, v26, s[4:7], s81 offen offset:2304 sc1
    buffer_load_dword v156, v27, s[4:7], s81 offen offset:0 sc1
    buffer_load_dword v157, v27, s[4:7], s81 offen offset:2304 sc1
    buffer_load_dwordx2 v[158:159], v29, s[4:7], s81 offen sc1
    s_waitcnt vmcnt(5)
    s_branch CW74
CG73:
    s_add_u32 s85, s81, 4608
    buffer_load_dword v160, v28, s[4:7], s81 offen offset:0 sc1
    buffer_load_dword v161, v28, s[4:7], s81 offen offset:2304 sc1
    buffer_load_dword v162, v28, s[4:7], s85 offen offset:0 sc1
    buffer_load_dword v163, v28, s[4:7], s85 offen offset:2304 sc1
    s_sub_u32 s84, s84, 1
    s_cbranch_scc1 L_END
T_Mg1_2:
    s_cbranch_execz T_Mg1_3
    s_waitcnt vmcnt(0)
CW74:
    v_max3_u32 v4, v160, v161, v162
    v_max_u32 v4, v4, v163
    v_cmp_eq_u32 vcc, -1, v4
    v_add_f32 v4, v160, v161
    v_add_f32 v5, v162, v163
    s_cbranch_vccnz CG73
    v_add_f32 v28, v4, v5
    s_branch PW72
PG71:
    buffer_load_dword v154, v26, s[4:7], s81 offen offset:0 sc1
    buffer_load_dword v155, v26, s[4:7], s81 offen offset:2304 sc1
    buffer_load_dword v156, v27, s[4:7], s81 offen offset:0 sc1
    buffer_load_dword v157, v27, s[4:7], s81 offen offset:2304 sc1
    buffer_load_dwordx2 v[158:159], v29, s[4:7], s81 offen sc1
    s_sub_u32 s84, s84, 1
    s_cbranch_scc1 L_END
T_Mg1_3:
    s_cbranch_execz T_Mg1_4
PW72:
    s_waitcnt vmcnt(0)
    v_max3_u32 v4, v154, v155, v156
    v_max3_u32 v4, v157, v159, v4
    v_cmp_eq_u32 vcc, -1, v4
    v_add_f32_dpp v150, v158, v158 quad_perm:[1,0,3,2] row_mask:0xf bank_mask:0xf
    v_add_f32_dpp v151, v159, v159 quad_perm:[1,0,3,2] row_mask:0xf bank_mask:0xf
    v_add_f32 v146, v154, v155
    v_add_f32_dpp v150, v150, v150 quad_perm:[2,3,0,1] row_mask:0xf bank_mask:0xf
    v_add_f32_dpp v151, v151, v151 quad_perm:[2,3,0,1] row_mask:0xf bank_mask:0xf
    s_cbranch_vccnz PG71
    v_mul_f32 v4, 0x3ae38e39, v150
    v_fmamk_f32 v151, v151, 0x3ae38e39, v35
    v_fma_f32 v151, -v4, v4, v151
    v_max_f32 v151, v151, v35
    v_rsq_f32 v5, v151
    v_add_f32 v148, v156, v157
    v_add_f32 v146, v146, v148
    v_fma_f32 v146, -v4, v28, v146
    v_fma_f32 v146, v146, v5, v34
    v_mul_f32 v4, v146, v146
    v_fmamk_f32 v4, v4, 0xbdd2d3e8, v7
    v_mul_f32 v4, v4, v146
    v_exp_f32 v4, v4
    s_nop 0
    v_add_f32 v4, 1.0, v4
    v_rcp_f32 v4, v4
    s_nop 0
    v_mul_f32 v146, v146, v4
    v_cvt_pk_bf16_f32 v146, v146, v146
    ds_write_b16 v30, v146
    ds_read_b128 v[150:153], v31
    s_waitcnt lgkmcnt(0)
    v_mfma_f32_16x16x32_bf16 v[126:129], v[150:153], v[106:109], 0
    v_mfma_f32_16x16x32_bf16 v[130:133], v[150:153], v[110:113], 0
    v_mfma_f32_16x16x32_bf16 v[134:137], v[150:153], v[114:117], 0
    v_mfma_f32_16x16x32_bf16 v[138:141], v[150:153], v[118:121], 0
    v_mfma_f32_16x16x32_bf16 v[142:145], v[150:153], v[122:125], 0
    s_mov_b64 exec, 0xffff
    s_nop 2
    ds_write2st64_b32 v22, v126, v127 offset0:0 offset1:15
    ds_write2st64_b32 v22, v130, v131 offset0:3 offset1:18
    ds_write2st64_b32 v22, v134, v135 offset0:6 offset1:21
    ds_write2st64_b32 v22, v138, v139 offset0:9 offset1:24
    ds_write2st64_b32 v22, v142, v143 offset0:12 offset1:27
    s_mov_b64 exec, -1
    s_mov_b32 s83, 1179648
    s_mov_b32 s86, 1187840
    s_mov_b32 s85, 1441792
    s_mov_b32 s87, 1449984
    v_mov_b32 v7, -1
    s_waitcnt lgkmcnt(0)
    s_barrier
    ds_read_b128 v[146:149], v23 offset:0
    ds_read_b128 v[150:153], v23 offset:3840
    ds_read2st64_b32 v[126:127], v24 offset0:0 offset1:15
    s_waitcnt lgkmcnt(2)
    v_pk_add_f32 v[146:147], v[146:147], v[148:149]
    s_waitcnt lgkmcnt(1)
    v_pk_add_f32 v[150:151], v[150:151], v[152:153]
    v_add_f32 v146, v146, v147
    v_add_f32 v147, v150, v151
    s_waitcnt lgkmcnt(0)
    v_pk_add_f32 v[146:147], v[146:147], v[126:127]
    s_nop 1
    v_add_f32_dpp v146, v146, v146 quad_perm:[1,0,3,2] row_mask:0xf bank_mask:0xf
    v_add_f32_dpp v147, v147, v147 quad_perm:[1,0,3,2] row_mask:0xf bank_mask:0xf
    s_mov_b64 exec, s[98:99]
    v_cvt_pk_bf16_f32 v146, v146, v147
    buffer_store_dword v146, v25, s[4:7], s86 offen sc1
    buffer_store_dword v146, v25, s[4:7], s83 offen sc1
    s_and_b64 exec, s[100:101], s[90:91]
    buffer_store_dword v1, off, s[4:7], s80 offset:1024
    s_and_b64 exec, s[100:101], s[92:93]
    buffer_store_dword v1, off, s[4:7], s80 offset:1024 sc1
    s_mov_b64 exec, -1
    s_mov_b64 exec, s[98:99]
    buffer_store_dword v7, v25, s[4:7], s85 offen sc1
    buffer_store_dword v7, v25, s[4:7], s87 offen sc1
    s_mov_b64 exec, -1
    s_barrier
    v_mov_b32 v144, 0
    v_mov_b32 v145, 0
    s_mov_b32 s83, 1179648
    s_barrier
    s_add_u32 s80, s80, 63488
    s_mov_b64 vcc, -1
XG75:
    s_mov_b64 exec, vcc
    buffer_load_dwordx4 v[154:157], v8, s[4:7], s83 offen sc1
    s_mov_b64 exec, -1
    s_sub_u32 s84, s84, 1
    s_cbranch_scc1 L_END
T_Mg1_4:
    s_cbranch_execz T_Mg1_5
    s_waitcnt vmcnt(0)
XW76:
    v_mfma_f32_16x16x32_bf16 v[146:149], v[154:157], v[164:167], 0
    v_max3_u32 v4, v154, v155, v156
    v_max_u32 v4, v4, v157
    v_cmp_eq_u32 vcc, -1, v4
    s_nop 1
    s_cbranch_vccnz XG75
    s_nop 1
    v_permlane32_swap_b32 v146, v147
    v_permlane32_swap_b32 v148, v149
    v_add_f32 v146, v146, v147
    v_add_f32 v148, v148, v149
    s_nop 1
    v_permlane16_swap_b32 v146, v148
    v_add_f32 v146, v146, v32
    v_add_f32 v146, v146, v148
    v_cvt_pk_bf16_f32 v146, v146, v146
    ds_write_b16 v9, v146 offset:42496
    v_lshlrev_b32 v32, 16, v146
    s_waitcnt lgkmcnt(0)
    s_barrier
    ds_read_b128 v[126:129], v10 offset:42496
    ds_read_b128 v[130:133], v10 offset:42560
    ds_read_b128 v[134:137], v10 offset:42624
    ds_read_b128 v[138:141], v10 offset:42688
    ds_read_b64 v[142:143], v11 offset:42752
    s_waitcnt lgkmcnt(4)
    v_mfma_f32_16x16x32_bf16 v[146:149], v[68:71], v[126:129], 0
    s_waitcnt lgkmcnt(3)
    v_mfma_f32_16x16x32_bf16 v[146:149], v[72:75], v[130:133], v[146:149]
    s_waitcnt lgkmcnt(2)
    v_mfma_f32_16x16x32_bf16 v[146:149], v[76:79], v[134:137], v[146:149]
    s_waitcnt lgkmcnt(1)
    v_mfma_f32_16x16x32_bf16 v[146:149], v[80:83], v[138:141], v[146:149]
    s_waitcnt lgkmcnt(0)
    v_mfma_f32_16x16x32_bf16 v[146:149], v[84:87], v[142:145], v[146:149]
    s_and_b64 exec, s[96:97], s[90:91]
    s_nop 6
    buffer_store_dwordx4 v[146:149], v12, s[4:7], s82 offen
    s_and_b64 exec, s[96:97], s[92:93]
    buffer_store_dwordx4 v[146:149], v12, s[4:7], s82 offen sc1
    s_mov_b64 exec, -1
    s_barrier
    buffer_load_dword v154, v14, s[4:7], s82 offen offset:0 sc1
    buffer_load_dword v155, v14, s[4:7], s82 offen offset:256 sc1
    buffer_load_dword v156, v14, s[4:7], s82 offen offset:512 sc1
    buffer_load_dword v157, v14, s[4:7], s82 offen offset:768 sc1
    buffer_load_dwordx2 v[158:159], v16, s[4:7], s82 offen sc1
    v_mov_b32 v4, 44872
    ds_read_b64 v[152:153], v4
    v_or_b32 v5, 8192, v8
    v_and_b32 v8, 0xffffdfff, v8
    s_waitcnt lgkmcnt(0)
    v_cmp_lt_u32 vcc, v153, v152
    s_nop 1
    v_cndmask_b32 v8, v8, v5, vcc
PG77:
    buffer_load_dword v154, v14, s[4:7], s82 offen offset:0 sc1
    buffer_load_dword v155, v14, s[4:7], s82 offen offset:256 sc1
    buffer_load_dword v156, v14, s[4:7], s82 offen offset:512 sc1
    buffer_load_dword v157, v14, s[4:7], s82 offen offset:768 sc1
    buffer_load_dwordx2 v[158:159], v16, s[4:7], s82 offen sc1
    s_sub_u32 s84, s84, 1
    s_cbranch_scc1 L_END
T_Mg1_5:
    s_cbranch_execz T_Mg1_6
PW78:
    s_waitcnt vmcnt(5)
    v_max3_u32 v4, v154, v155, v156
    v_max3_u32 v4, v157, v159, v4
    v_max_u32 v4, v4, v158
    v_cmp_eq_u32 vcc, -1, v4
    v_add_f32_dpp v150, v158, v158 quad_perm:[1,0,3,2] row_mask:0xf bank_mask:0xf
    v_add_f32_dpp v151, v159, v159 quad_perm:[1,0,3,2] row_mask:0xf bank_mask:0xf
    v_add_f32 v146, v154, v155
    v_add_f32_dpp v150, v150, v150 quad_perm:[2,3,0,1] row_mask:0xf bank_mask:0xf
    v_add_f32_dpp v151, v151, v151 quad_perm:[2,3,0,1] row_mask:0xf bank_mask:0xf
    s_cbranch_vccnz PG77
    v_mul_f32 v4, 0x3ae38e39, v150
    v_fmamk_f32 v151, v151, 0x3ae38e39, v35
    v_fma_f32 v151, -v4, v4, v151
    v_max_f32 v151, v151, v35
    v_rsq_f32 v5, v151
    v_add_f32 v148, v156, v157
    v_add_f32 v146, v146, v148
    v_fma_f32 v146, -v4, v15, v146
    v_mul_f32 v5, 0x3e0293ee, v5
    v_mul_f32 v146, v146, v5
    v_cvt_pk_bf16_f32 v146, v146, v146
    ds_write_b16 v17, v146 offset:43520
    s_waitcnt lgkmcnt(0)
    s_barrier
    ds_read_b128 v[126:129], v18 offset:43520
    ds_read_b128 v[130:133], v18 offset:43584
    ds_read_b128 v[134:137], v18 offset:43648
    ds_read_b128 v[138:141], v18 offset:43712
    s_waitcnt lgkmcnt(3)
    v_mfma_f32_16x16x32_bf16 v[146:149], v[36:39], v[126:129], 0
    v_mfma_f32_16x16x32_bf16 v[150:153], v[52:55], v[126:129], 0
    s_waitcnt lgkmcnt(2)
    v_mfma_f32_16x16x32_bf16 v[146:149], v[40:43], v[130:133], v[146:149]
    v_mfma_f32_16x16x32_bf16 v[150:153], v[56:59], v[130:133], v[150:153]
    s_waitcnt lgkmcnt(1)
    v_mfma_f32_16x16x32_bf16 v[146:149], v[44:47], v[134:137], v[146:149]
    v_mfma_f32_16x16x32_bf16 v[150:153], v[60:63], v[134:137], v[150:153]
    s_waitcnt lgkmcnt(0)
    v_mfma_f32_16x16x32_bf16 v[146:149], v[48:51], v[138:141], v[146:149]
    v_mfma_f32_16x16x32_bf16 v[150:153], v[64:67], v[138:141], v[150:153]
    s_mov_b64 exec, s[96:97]
    s_nop 5
    v_max3_f32 v4, v146, v147, v148
    v_max3_f32 v5, v150, v151, v152
    v_max3_f32 v4, v4, v149, v153
    v_max_f32 v4, v4, v5
    ds_max_f32 v19, v4 offset:44832
    s_mov_b64 exec, -1
    v_cndmask_b32 v146, v146, v150, s[38:39]
    v_cndmask_b32 v147, v147, v151, s[38:39]
    v_cndmask_b32 v148, v148, v152, s[38:39]
    v_cndmask_b32 v149, v149, v153, s[38:39]
    v_cndmask_b32 v146, v146, v148, s[36:37]
    v_cndmask_b32 v147, v147, v149, s[36:37]
    v_cndmask_b32 v146, v146, v147, s[34:35]
    s_waitcnt lgkmcnt(0)
    s_barrier
    ds_read_b128 v[142:145], v20 offset:44832
    s_waitcnt lgkmcnt(0)
    v_max3_f32 v4, v142, v143, v144
    v_max_f32 v4, v4, v145
    v_sub_f32 v146, v146, v4
    v_exp_f32 v146, v146
    s_nop 0
    v_cvt_pk_bf16_f32 v146, v146, v146
    ds_write_b16 v21, v146 offset:44160
    s_waitcnt lgkmcnt(0)
    s_barrier
    s_barrier
    s_cmp_ge_u32 s75, 4
    s_cbranch_scc1 PK79
    s_andn2_b32 s86, s33, 8192
    s_or_b32 s87, s33, 8192
    v_mov_b32 v4, 0
    s_memtime s[24:25]
    s_load_dword s30, s[72:73], s86 glc
    s_waitcnt lgkmcnt(0)
    s_memtime s[26:27]
    s_load_dword s30, s[72:73], s87 glc
    s_waitcnt lgkmcnt(0)
    s_memtime s[28:29]
    s_sub_u32 s86, s26, s24
    v_mov_b32 v5, s86
    s_waitcnt lgkmcnt(0)
    s_sub_u32 s87, s28, s26
    v_mov_b32 v6, s87
    s_mov_b64 exec, 1
    ds_min_u32 v4, v5 offset:44872
    ds_min_u32 v4, v6 offset:44876
    s_mov_b64 exec, -1
PK79:
    v_mov_b32 v142, 0
    v_mov_b32 v143, 0
    s_mov_b32 s83, 1310720
    s_mov_b64 exec, 1
HW80:
    buffer_load_dword v4, off, s[4:7], s80 offset:0 sc1
    s_sub_u32 s84, s84, 1
    s_cbranch_scc1 L_END
T_Mg1_6:
    s_cbranch_execz T_Mg1_7
    s_waitcnt vmcnt(0)
    v_cmp_eq_u32 vcc, -1, v4
    s_cbranch_vccnz HW80
    s_mov_b64 exec, -1
    v_mov_b32 v4, 44872
    ds_read_b64 v[152:153], v4
    v_or_b32 v5, 8192, v8
    v_and_b32 v8, 0xffffdfff, v8
    s_waitcnt lgkmcnt(0)
    v_cmp_lt_u32 vcc, v153, v152
    s_nop 1
    v_cndmask_b32 v8, v8, v5, vcc
    s_mov_b64 vcc, -1
XG81:
    s_mov_b64 exec, vcc
    buffer_load_dwordx4 v[154:157], v8, s[4:7], s83 offen sc1
    s_mov_b64 exec, -1
    s_sub_u32 s84, s84, 1
    s_cbranch_scc1 L_END
T_Mg1_7:
    s_cbranch_execz T_Mg1_8
    s_waitcnt vmcnt(0)
XW82:
    v_mfma_f32_16x16x32_bf16 v[146:149], v[154:157], v[164:167], 0
    v_max3_u32 v4, v154, v155, v156
    v_max_u32 v4, v4, v157
    v_cmp_eq_u32 vcc, -1, v4
    s_nop 1
    s_cbranch_vccnz XG81
    s_nop 1
    v_permlane32_swap_b32 v146, v147
    v_permlane32_swap_b32 v148, v149
    v_add_f32 v146, v146, v147
    v_add_f32 v148, v148, v149
    s_nop 1
    v_permlane16_swap_b32 v146, v148
    v_add_f32 v146, v146, v32
    v_add_f32 v146, v146, v148
    v_cvt_pk_bf16_f32 v146, v146, v146
    ds_write_b16 v9, v146 offset:42496
    v_lshlrev_b32 v32, 16, v146
    v_add_f32 v32, v32, v33
    s_waitcnt lgkmcnt(0)
    s_barrier
    ds_read_b128 v[126:129], v10 offset:42496
    ds_read_b128 v[130:133], v10 offset:42560
    ds_read_b128 v[134:137], v10 offset:42624
    ds_read_b128 v[138:141], v10 offset:42688
    ds_read_b64 v[144:145], v11 offset:42752
    s_waitcnt lgkmcnt(4)
    v_mfma_f32_16x16x32_bf16 v[146:149], v[90:93], v[126:129], 0
    s_waitcnt lgkmcnt(3)
    v_mfma_f32_16x16x32_bf16 v[146:149], v[94:97], v[130:133], v[146:149]
    s_waitcnt lgkmcnt(2)
    v_mfma_f32_16x16x32_bf16 v[146:149], v[98:101], v[134:137], v[146:149]
    s_waitcnt lgkmcnt(1)
    v_mfma_f32_16x16x32_bf16 v[146:149], v[102:105], v[138:141], v[146:149]
    s_waitcnt lgkmcnt(0)
    v_mfma_f32_16x16x32_bf16 v[146:149], v[86:89], v[142:145], v[146:149]
    s_and_b64 exec, s[96:97], s[90:91]
    s_nop 6
    buffer_store_dwordx4 v[146:149], v13, s[4:7], s82 offen
    s_and_b64 exec, s[96:97], s[92:93]
    buffer_store_dwordx4 v[146:149], v13, s[4:7], s82 offen sc1
    s_mov_b64 exec, -1
    v_mov_b32 v7, 0xc0135761
    s_barrier
PG83:
    buffer_load_dword v154, v26, s[4:7], s82 offen offset:0 sc1
    buffer_load_dword v155, v26, s[4:7], s82 offen offset:2304 sc1
    buffer_load_dword v156, v27, s[4:7], s82 offen offset:0 sc1
    buffer_load_dword v157, v27, s[4:7], s82 offen offset:2304 sc1
    buffer_load_dwordx2 v[158:159], v29, s[4:7], s82 offen sc1
    s_sub_u32 s84, s84, 1
    s_cbranch_scc1 L_END
T_Mg1_8:
    s_cbranch_execz T_Mg1_9
PW84:
    s_waitcnt vmcnt(0)
    v_max3_u32 v4, v154, v155, v156
    v_max3_u32 v4, v157, v159, v4
    v_cmp_eq_u32 vcc, -1, v4
    v_add_f32_dpp v150, v158, v158 quad_perm:[1,0,3,2] row_mask:0xf bank_mask:0xf
    v_add_f32_dpp v151, v159, v159 quad_perm:[1,0,3,2] row_mask:0xf bank_mask:0xf
    v_add_f32 v146, v154, v155
    v_add_f32_dpp v150, v150, v150 quad_perm:[2,3,0,1] row_mask:0xf bank_mask:0xf
    v_add_f32_dpp v151, v151, v151 quad_perm:[2,3,0,1] row_mask:0xf bank_mask:0xf
    s_cbranch_vccnz PG83
    v_mul_f32 v4, 0x3ae38e39, v150
    v_fmamk_f32 v151, v151, 0x3ae38e39, v35
    v_fma_f32 v151, -v4, v4, v151
    v_max_f32 v151, v151, v35
    v_rsq_f32 v5, v151
    v_add_f32 v148, v156, v157
    v_add_f32 v146, v146, v148
    v_fma_f32 v146, -v4, v28, v146
    v_fma_f32 v146, v146, v5, v34
    v_mul_f32 v4, v146, v146
    v_fmamk_f32 v4, v4, 0xbdd2d3e8, v7
    v_mul_f32 v4, v4, v146
    v_exp_f32 v4, v4
    s_nop 0
    v_add_f32 v4, 1.0, v4
    v_rcp_f32 v4, v4
    s_nop 0
    v_mul_f32 v146, v146, v4
    v_cvt_pk_bf16_f32 v146, v146, v146
    ds_write_b16 v30, v146
    ds_read_b128 v[150:153], v31
    s_waitcnt lgkmcnt(0)
    v_mfma_f32_16x16x32_bf16 v[126:129], v[150:153], v[106:109], 0
    v_mfma_f32_16x16x32_bf16 v[130:133], v[150:153], v[110:113], 0
    v_mfma_f32_16x16x32_bf16 v[134:137], v[150:153], v[114:117], 0
    v_mfma_f32_16x16x32_bf16 v[138:141], v[150:153], v[118:121], 0
    v_mfma_f32_16x16x32_bf16 v[142:145], v[150:153], v[122:125], 0
    s_mov_b64 exec, 0xffff
    s_nop 2
    ds_write2st64_b32 v22, v126, v127 offset0:0 offset1:15
    ds_write2st64_b32 v22, v130, v131 offset0:3 offset1:18
    ds_write2st64_b32 v22, v134, v135 offset0:6 offset1:21
    ds_write2st64_b32 v22, v138, v139 offset0:9 offset1:24
    ds_write2st64_b32 v22, v142, v143 offset0:12 offset1:27
    s_mov_b64 exec, -1
    s_mov_b32 s83, 1441792
    s_mov_b32 s86, 1449984
    s_waitcnt lgkmcnt(0)
    s_barrier
    ds_read_b128 v[146:149], v23 offset:0
    ds_read_b128 v[150:153], v23 offset:3840
    ds_read2st64_b32 v[126:127], v24 offset0:0 offset1:15
    s_waitcnt lgkmcnt(2)
    v_pk_add_f32 v[146:147], v[146:147], v[148:149]
    s_waitcnt lgkmcnt(1)
    v_pk_add_f32 v[150:151], v[150:151], v[152:153]
    v_add_f32 v146, v146, v147
    v_add_f32 v147, v150, v151
    s_waitcnt lgkmcnt(0)
    v_pk_add_f32 v[146:147], v[146:147], v[126:127]
    s_nop 1
    v_add_f32_dpp v146, v146, v146 quad_perm:[1,0,3,2] row_mask:0xf bank_mask:0xf
    v_add_f32_dpp v147, v147, v147 quad_perm:[1,0,3,2] row_mask:0xf bank_mask:0xf
    s_mov_b64 exec, s[98:99]
    v_cvt_pk_bf16_f32 v146, v146, v147
    buffer_store_dword v146, v25, s[4:7], s86 offen sc1
    buffer_store_dword v146, v25, s[4:7], s83 offen sc1
    s_and_b64 exec, s[100:101], s[90:91]
    buffer_store_dword v1, off, s[4:7], s80 offset:1024
    s_and_b64 exec, s[100:101], s[92:93]
    buffer_store_dword v1, off, s[4:7], s80 offset:1024 sc1
    s_mov_b64 exec, -1
    s_mov_b64 exec, s[98:99]
    s_mov_b64 exec, -1
    s_barrier
    s_and_b32 s85, s2, 63
    s_cbranch_scc0 GO85
    s_endpgm
GO85:
    v_and_b32 v4, 1, v1
    v_mul_u32_u24 v4, 832, v4
    s_mul_i32 s85, s78, 288
    v_add3_u32 v9, v9, v4, s85
    s_mov_b32 s83, 1441792
    s_barrier
    s_mov_b64 vcc, -1
XG86:
    s_mov_b64 exec, vcc
    buffer_load_dwordx4 v[154:157], v8, s[4:7], s83 offen sc1
    s_mov_b64 exec, -1
    s_sub_u32 s84, s84, 1
    s_cbranch_scc1 L_END
T_Mg1_9:
    s_cbranch_execz T_Mg1_10
    s_waitcnt vmcnt(0)
XW87:
    v_mfma_f32_16x16x32_bf16 v[146:149], v[154:157], v[164:167], 0
    v_max3_u32 v4, v154, v155, v156
    v_max_u32 v4, v4, v157
    v_cmp_eq_u32 vcc, -1, v4
    s_nop 1
    s_cbranch_vccnz XG86
    s_nop 1
    v_permlane32_swap_b32 v146, v147
    v_permlane32_swap_b32 v148, v149
    v_add_f32 v146, v146, v147
    v_add_f32 v148, v148, v149
    s_nop 1
    v_permlane16_swap_b32 v146, v148
    v_add_f32 v146, v146, v32
    v_add_f32 v146, v146, v148
    v_cvt_pk_bf16_f32 v146, v146, v146
    buffer_store_short v146, v9, s[8:11], 0 offen
    s_endpgm
T_Mg1_10:
    s_branch U_Mg1
    .p2align 12
T_Mg2:
    s_branch T_Mg2_1
B_Mg2:
    s_waitcnt lgkmcnt(0)
    s_barrier
    s_barrier
    s_waitcnt lgkmcnt(0)
    s_barrier
    ds_read_b128 v[126:129], v18 offset:44160
    ds_read_b128 v[130:133], v18 offset:44224
    ds_read_b128 v[134:137], v18 offset:44288
    ds_read_b128 v[138:141], v18 offset:44352
    ds_read_b64_tr_b16 v[36:37], v67 offset:0
    ds_read_b64_tr_b16 v[38:39], v67 offset:1024
    ds_read_b64_tr_b16 v[52:53], v67 offset:8
    ds_read_b64_tr_b16 v[54:55], v67 offset:1032
    ds_read_b64_tr_b16 v[40:41], v67 offset:8192
    ds_read_b64_tr_b16 v[42:43], v67 offset:9216
    ds_read_b64_tr_b16 v[56:57], v67 offset:8200
    ds_read_b64_tr_b16 v[58:59], v67 offset:9224
    ds_read_b64_tr_b16 v[44:45], v67 offset:16384
    ds_read_b64_tr_b16 v[46:47], v67 offset:17408
    ds_read_b64_tr_b16 v[60:61], v67 offset:16392
    ds_read_b64_tr_b16 v[62:63], v67 offset:17416
    s_waitcnt lgkmcnt(8)
    v_mfma_f32_16x16x32_bf16 v[146:149], v[36:39], v[126:129], 0
    v_mfma_f32_16x16x32_bf16 v[150:153], v[52:55], v[126:129], 0
    s_waitcnt lgkmcnt(4)
    v_mfma_f32_16x16x32_bf16 v[146:149], v[40:43], v[130:133], v[146:149]
    v_mfma_f32_16x16x32_bf16 v[150:153], v[56:59], v[130:133], v[150:153]
    s_waitcnt lgkmcnt(0)
    v_mfma_f32_16x16x32_bf16 v[146:149], v[44:47], v[134:137], v[146:149]
    v_mfma_f32_16x16x32_bf16 v[150:153], v[60:63], v[134:137], v[150:153]
    s_barrier
    ds_read_b64_tr_b16 v[48:49], v67 offset:24576
    ds_read_b64_tr_b16 v[50:51], v67 offset:25600
    ds_read_b64_tr_b16 v[64:65], v67 offset:24584
    ds_read_b64_tr_b16 v[66:67], v67 offset:25608
    s_waitcnt lgkmcnt(0)
    v_mfma_f32_16x16x32_bf16 v[146:149], v[48:51], v[138:141], v[146:149]
    v_mfma_f32_16x16x32_bf16 v[150:153], v[64:67], v[138:141], v[150:153]
    s_nop 6
    v_cvt_pk_bf16_f32 v146, v146, v147
    v_cvt_pk_bf16_f32 v147, v148, v149
    v_cvt_pk_bf16_f32 v148, v150, v151
    v_cvt_pk_bf16_f32 v149, v152, v153
    s_and_b64 exec, s[96:97], s[90:91]
    buffer_store_dwordx4 v[146:149], v12, s[4:7], s81 offen
    s_and_b64 exec, s[96:97], s[92:93]
    buffer_store_dwordx4 v[146:149], v12, s[4:7], s81 offen sc1
    s_mov_b64 exec, -1
    s_barrier
    s_waitcnt lgkmcnt(0)
    s_barrier
    v_mov_b32 v142, 0
    v_mov_b32 v143, 0
    v_mov_b32 v4, 44872
    ds_read_b64 v[152:153], v4
    v_or_b32 v5, 8192, v8
    v_and_b32 v8, 0xffffdfff, v8
    s_waitcnt lgkmcnt(0)
    v_cmp_lt_u32 vcc, v153, v152
    s_nop 1
    v_cndmask_b32 v8, v8, v5, vcc
    s_mov_b32 s83, 1048576
    buffer_load_dwordx4 v[154:157], v8, s[4:7], s83 offen sc1
    ds_read_b64_tr_b16 v[106:107], v125 offset:0
    ds_read_b64_tr_b16 v[108:109], v125 offset:576
    ds_read_b64_tr_b16 v[110:111], v125 offset:32
    ds_read_b64_tr_b16 v[112:113], v125 offset:608
    ds_read_b64_tr_b16 v[114:115], v125 offset:64
    ds_read_b64_tr_b16 v[116:117], v125 offset:640
    ds_read_b64_tr_b16 v[118:119], v125 offset:96
    ds_read_b64_tr_b16 v[120:121], v125 offset:672
    ds_read_b64_tr_b16 v[122:123], v125 offset:128
    ds_read_b64_tr_b16 v[124:125], v125 offset:704
    s_waitcnt vmcnt(0)
    s_branch XW92
XG91:
    s_mov_b64 exec, vcc
    buffer_load_dwordx4 v[154:157], v8, s[4:7], s83 offen sc1
    s_mov_b64 exec, -1
    s_sub_u32 s84, s84, 1
    s_cbranch_scc1 L_END
T_Mg2_1:
    s_cbranch_execz T_Mg2_2
    s_waitcnt vmcnt(0)
XW92:
    v_mfma_f32_16x16x32_bf16 v[146:149], v[154:157], v[164:167], 0
    v_max3_u32 v4, v154, v155, v156
    v_max_u32 v4, v4, v157
    v_cmp_eq_u32 vcc, -1, v4
    s_nop 1
    s_cbranch_vccnz XG91
    s_nop 1
    v_permlane32_swap_b32 v146, v147
    v_permlane32_swap_b32 v148, v149
    v_add_f32 v146, v146, v147
    v_add_f32 v148, v148, v149
    s_nop 1
    v_permlane16_swap_b32 v146, v148
    v_add_f32 v146, v146, v32
    v_add_f32 v146, v146, v148
    v_cvt_pk_bf16_f32 v146, v146, v146
    ds_write_b16 v9, v146 offset:42496
    v_lshlrev_b32 v32, 16, v146
    v_add_f32 v32, v32, v33
    s_add_u32 s85, s81, 4608
    buffer_load_dword v160, v28, s[4:7], s81 offen offset:0 sc1
    buffer_load_dword v161, v28, s[4:7], s81 offen offset:2304 sc1
    buffer_load_dword v162, v28, s[4:7], s85 offen offset:0 sc1
    buffer_load_dword v163, v28, s[4:7], s85 offen offset:2304 sc1
    s_waitcnt lgkmcnt(0)
    s_barrier
    s_cmp_lg_u32 s79, 0
    s_cbranch_scc1 GS93
    ds_read_b128 v[126:129], v10 offset:42496
    ds_read_b128 v[130:133], v10 offset:42560
    ds_read_b128 v[134:137], v10 offset:42624
    ds_read_b128 v[138:141], v10 offset:42688
    ds_read_b64 v[144:145], v11 offset:42752
    v_cmp_eq_u32 vcc, 1, v1
    s_waitcnt lgkmcnt(4)
    v_mfma_f32_16x16x32_bf16 v[146:149], v[126:129], v[126:129], 0
    s_waitcnt lgkmcnt(3)
    v_mfma_f32_16x16x32_bf16 v[146:149], v[130:133], v[130:133], v[146:149]
    s_waitcnt lgkmcnt(2)
    v_mfma_f32_16x16x32_bf16 v[146:149], v[134:137], v[134:137], v[146:149]
    s_waitcnt lgkmcnt(1)
    v_mfma_f32_16x16x32_bf16 v[146:149], v[138:141], v[138:141], v[146:149]
    s_waitcnt lgkmcnt(0)
    v_mfma_f32_16x16x32_bf16 v[146:149], v[142:145], v[142:145], v[146:149]
    s_nop 7
    v_cndmask_b32 v149, v146, v147, vcc
    s_and_b64 exec, 3, s[90:91]
    buffer_store_dwordx2 v[148:149], v14, s[4:7], s81 offen offset:256
    s_and_b64 exec, 3, s[92:93]
    buffer_store_dwordx2 v[148:149], v14, s[4:7], s81 offen offset:256 sc1
    s_mov_b64 exec, -1
GS93:
    v_mov_b32 v7, 0xc0135761
    s_barrier
    buffer_load_dword v154, v26, s[4:7], s81 offen offset:0 sc1
    buffer_load_dword v155, v26, s[4:7], s81 offen offset:2304 sc1
    buffer_load_dword v156, v27, s[4:7], s81 offen offset:0 sc1
    buffer_load_dword v157, v27, s[4:7], s81 offen offset:2304 sc1
    buffer_load_dwordx2 v[158:159], v29, s[4:7], s81 offen sc1
    s_waitcnt vmcnt(5)
    s_branch CW97
CG96:
    s_add_u32 s85, s81, 4608
    buffer_load_dword v160, v28, s[4:7], s81 offen offset:0 sc1
    buffer_load_dword v161, v28, s[4:7], s81 offen offset:2304 sc1
    buffer_load_dword v162, v28, s[4:7], s85 offen offset:0 sc1
    buffer_load_dword v163, v28, s[4:7], s85 offen offset:2304 sc1
    s_sub_u32 s84, s84, 1
    s_cbranch_scc1 L_END
T_Mg2_2:
    s_cbranch_execz T_Mg2_3
    s_waitcnt vmcnt(0)
CW97:
    v_max3_u32 v4, v160, v161, v162
    v_max_u32 v4, v4, v163
    v_cmp_eq_u32 vcc, -1, v4
    v_add_f32 v4, v160, v161
    v_add_f32 v5, v162, v163
    s_cbranch_vccnz CG96
    v_add_f32 v28, v4, v5
    s_branch PW95
PG94:
    buffer_load_dword v154, v26, s[4:7], s81 offen offset:0 sc1
    buffer_load_dword v155, v26, s[4:7], s81 offen offset:2304 sc1
    buffer_load_dword v156, v27, s[4:7], s81 offen offset:0 sc1
    buffer_load_dword v157, v27, s[4:7], s81 offen offset:2304 sc1
    buffer_load_dwordx2 v[158:159], v29, s[4:7], s81 offen sc1
    s_sub_u32 s84, s84, 1
    s_cbranch_scc1 L_END
T_Mg2_3:
    s_cbranch_execz T_Mg2_4
PW95:
    s_waitcnt vmcnt(0)
    v_max3_u32 v4, v154, v155, v156
    v_max3_u32 v4, v157, v159, v4
    v_cmp_eq_u32 vcc, -1, v4
    v_add_f32_dpp v150, v158, v158 quad_perm:[1,0,3,2] row_mask:0xf bank_mask:0xf
    v_add_f32_dpp v151, v159, v159 quad_perm:[1,0,3,2] row_mask:0xf bank_mask:0xf
    v_add_f32 v146, v154, v155
    v_add_f32_dpp v150, v150, v150 quad_perm:[2,3,0,1] row_mask:0xf bank_mask:0xf
    v_add_f32_dpp v151, v151, v151 quad_perm:[2,3,0,1] row_mask:0xf bank_mask:0xf
    s_cbranch_vccnz PG94
    v_mul_f32 v4, 0x3ae38e39, v150
    v_fmamk_f32 v151, v151, 0x3ae38e39, v35
    v_fma_f32 v151, -v4, v4, v151
    v_max_f32 v151, v151, v35
    v_rsq_f32 v5, v151
    v_add_f32 v148, v156, v157
    v_add_f32 v146, v146, v148
    v_fma_f32 v146, -v4, v28, v146
    v_fma_f32 v146, v146, v5, v34
    v_mul_f32 v4, v146, v146
    v_fmamk_f32 v4, v4, 0xbdd2d3e8, v7
    v_mul_f32 v4, v4, v146
    v_exp_f32 v4, v4
    s_nop 0
    v_add_f32 v4, 1.0, v4
    v_rcp_f32 v4, v4
    s_nop 0
    v_mul_f32 v146, v146, v4
    v_cvt_pk_bf16_f32 v146, v146, v146
    ds_write_b16 v30, v146
    ds_read_b128 v[150:153], v31
    s_waitcnt lgkmcnt(0)
    v_mfma_f32_16x16x32_bf16 v[126:129], v[150:153], v[106:109], 0
    v_mfma_f32_16x16x32_bf16 v[130:133], v[150:153], v[110:113], 0
    v_mfma_f32_16x16x32_bf16 v[134:137], v[150:153], v[114:117], 0
    v_mfma_f32_16x16x32_bf16 v[138:141], v[150:153], v[118:121], 0
    v_mfma_f32_16x16x32_bf16 v[142:145], v[150:153], v[122:125], 0
    s_mov_b64 exec, 0xffff
    s_nop 2
    ds_write2st64_b32 v22, v126, v127 offset0:0 offset1:15
    ds_write2st64_b32 v22, v130, v131 offset0:3 offset1:18
    ds_write2st64_b32 v22, v134, v135 offset0:6 offset1:21
    ds_write2st64_b32 v22, v138, v139 offset0:9 offset1:24
    ds_write2st64_b32 v22, v142, v143 offset0:12 offset1:27
    s_mov_b64 exec, -1
    s_waitcnt lgkmcnt(0)
    s_barrier
    s_barrier
    v_mov_b32 v144, 0
    v_mov_b32 v145, 0
    s_mov_b32 s83, 1179648
    s_barrier
    s_add_u32 s80, s80, 63488
    s_mov_b64 vcc, -1
XG98:
    s_mov_b64 exec, vcc
    buffer_load_dwordx4 v[154:157], v8, s[4:7], s83 offen sc1
    s_mov_b64 exec, -1
    s_sub_u32 s84, s84, 1
    s_cbranch_scc1 L_END
T_Mg2_4:
    s_cbranch_execz T_Mg2_5
    s_waitcnt vmcnt(0)
XW99:
    v_mfma_f32_16x16x32_bf16 v[146:149], v[154:157], v[164:167], 0
    v_max3_u32 v4, v154, v155, v156
    v_max_u32 v4, v4, v157
    v_cmp_eq_u32 vcc, -1, v4
    s_nop 1
    s_cbranch_vccnz XG98
    s_nop 1
    v_permlane32_swap_b32 v146, v147
    v_permlane32_swap_b32 v148, v149
    v_add_f32 v146, v146, v147
    v_add_f32 v148, v148, v149
    s_nop 1
    v_permlane16_swap_b32 v146, v148
    v_add_f32 v146, v146, v32
    v_add_f32 v146, v146, v148
    v_cvt_pk_bf16_f32 v146, v146, v146
    ds_write_b16 v9, v146 offset:42496
    v_lshlrev_b32 v32, 16, v146
    s_waitcnt lgkmcnt(0)
    s_barrier
    s_cmp_lg_u32 s79, 0
    s_cbranch_scc1 GS100
    ds_read_b128 v[126:129], v10 offset:42496
    ds_read_b128 v[130:133], v10 offset:42560
    ds_read_b128 v[134:137], v10 offset:42624
    ds_read_b128 v[138:141], v10 offset:42688
    ds_read_b64 v[142:143], v11 offset:42752
    v_cmp_eq_u32 vcc, 1, v1
    s_waitcnt lgkmcnt(4)
    v_mfma_f32_16x16x32_bf16 v[146:149], v[126:129], v[126:129], 0
    s_waitcnt lgkmcnt(3)
    v_mfma_f32_16x16x32_bf16 v[146:149], v[130:133], v[130:133], v[146:149]
    s_waitcnt lgkmcnt(2)
    v_mfma_f32_16x16x32_bf16 v[146:149], v[134:137], v[134:137], v[146:149]
    s_waitcnt lgkmcnt(1)
    v_mfma_f32_16x16x32_bf16 v[146:149], v[138:141], v[138:141], v[146:149]
    s_waitcnt lgkmcnt(0)
    v_mfma_f32_16x16x32_bf16 v[146:149], v[142:145], v[142:145], v[146:149]
    s_nop 7
    v_cndmask_b32 v149, v146, v147, vcc
    s_and_b64 exec, 3, s[90:91]
    buffer_store_dwordx2 v[148:149], v14, s[4:7], s82 offen
    s_and_b64 exec, 3, s[92:93]
    buffer_store_dwordx2 v[148:149], v14, s[4:7], s82 offen sc1
    s_mov_b64 exec, -1
GS100:
    s_barrier
    s_waitcnt lgkmcnt(0)
    s_barrier
    s_barrier
    s_barrier
    ds_read_b128 v[126:129], v18 offset:44160
    ds_read_b128 v[130:133], v18 offset:44224
    ds_read_b128 v[134:137], v18 offset:44288
    ds_read_b128 v[138:141], v18 offset:44352
    s_waitcnt lgkmcnt(3)
    v_mfma_f32_16x16x32_bf16 v[146:149], v[36:39], v[126:129], 0
    v_mfma_f32_16x16x32_bf16 v[150:153], v[52:55], v[126:129], 0
    s_waitcnt lgkmcnt(2)
    v_mfma_f32_16x16x32_bf16 v[146:149], v[40:43], v[130:133], v[146:149]
    v_mfma_f32_16x16x32_bf16 v[150:153], v[56:59], v[130:133], v[150:153]
    s_waitcnt lgkmcnt(1)
    v_mfma_f32_16x16x32_bf16 v[146:149], v[44:47], v[134:137], v[146:149]
    v_mfma_f32_16x16x32_bf16 v[150:153], v[60:63], v[134:137], v[150:153]
    s_waitcnt lgkmcnt(0)
    v_mfma_f32_16x16x32_bf16 v[146:149], v[48:51], v[138:141], v[146:149]
    v_mfma_f32_16x16x32_bf16 v[150:153], v[64:67], v[138:141], v[150:153]
    s_nop 6
    v_cvt_pk_bf16_f32 v146, v146, v147
    v_cvt_pk_bf16_f32 v147, v148, v149
    v_cvt_pk_bf16_f32 v148, v150, v151
    v_cvt_pk_bf16_f32 v149, v152, v153
    s_and_b64 exec, s[96:97], s[90:91]
    buffer_store_dwordx4 v[146:149], v12, s[4:7], s82 offen
    s_and_b64 exec, s[96:97], s[92:93]
    buffer_store_dwordx4 v[146:149], v12, s[4:7], s82 offen sc1
    s_mov_b64 exec, -1
    s_barrier
    v_mov_b32 v142, 0
    v_mov_b32 v143, 0
    s_mov_b32 s83, 1310720
    s_mov_b64 exec, 1
HW101:
    buffer_load_dword v4, off, s[4:7], s80 offset:0 sc1
    s_sub_u32 s84, s84, 1
    s_cbranch_scc1 L_END
T_Mg2_5:
    s_cbranch_execz T_Mg2_6
    s_waitcnt vmcnt(0)
    v_cmp_eq_u32 vcc, -1, v4
    s_cbranch_vccnz HW101
    s_mov_b64 exec, -1
    v_mov_b32 v4, 44872
    ds_read_b64 v[152:153], v4
    v_or_b32 v5, 8192, v8
    v_and_b32 v8, 0xffffdfff, v8
    s_waitcnt lgkmcnt(0)
    v_cmp_lt_u32 vcc, v153, v152
    s_nop 1
    v_cndmask_b32 v8, v8, v5, vcc
    s_mov_b64 vcc, -1
XG102:
    s_mov_b64 exec, vcc
    buffer_load_dwordx4 v[154:157], v8, s[4:7], s83 offen sc1
    s_mov_b64 exec, -1
    s_sub_u32 s84, s84, 1
    s_cbranch_scc1 L_END
T_Mg2_6:
    s_cbranch_execz T_Mg2_7
    s_waitcnt vmcnt(0)
XW103:
    v_mfma_f32_16x16x32_bf16 v[146:149], v[154:157], v[164:167], 0
    v_max3_u32 v4, v154, v155, v156
    v_max_u32 v4, v4, v157
    v_cmp_eq_u32 vcc, -1, v4
    s_nop 1
    s_cbranch_vccnz XG102
    s_nop 1
    v_permlane32_swap_b32 v146, v147
    v_permlane32_swap_b32 v148, v149
    v_add_f32 v146, v146, v147
    v_add_f32 v148, v148, v149
    s_nop 1
    v_permlane16_swap_b32 v146, v148
    v_add_f32 v146, v146, v32
    v_add_f32 v146, v146, v148
    v_cvt_pk_bf16_f32 v146, v146, v146
    ds_write_b16 v9, v146 offset:42496
    v_lshlrev_b32 v32, 16, v146
    v_add_f32 v32, v32, v33
    s_waitcnt lgkmcnt(0)
    s_barrier
    s_cmp_lg_u32 s79, 0
    s_cbranch_scc1 GS104
    ds_read_b128 v[126:129], v10 offset:42496
    ds_read_b128 v[130:133], v10 offset:42560
    ds_read_b128 v[134:137], v10 offset:42624
    ds_read_b128 v[138:141], v10 offset:42688
    ds_read_b64 v[144:145], v11 offset:42752
    v_cmp_eq_u32 vcc, 1, v1
    s_waitcnt lgkmcnt(4)
    v_mfma_f32_16x16x32_bf16 v[146:149], v[126:129], v[126:129], 0
    s_waitcnt lgkmcnt(3)
    v_mfma_f32_16x16x32_bf16 v[146:149], v[130:133], v[130:133], v[146:149]
    s_waitcnt lgkmcnt(2)
    v_mfma_f32_16x16x32_bf16 v[146:149], v[134:137], v[134:137], v[146:149]
    s_waitcnt lgkmcnt(1)
    v_mfma_f32_16x16x32_bf16 v[146:149], v[138:141], v[138:141], v[146:149]
    s_waitcnt lgkmcnt(0)
    v_mfma_f32_16x16x32_bf16 v[146:149], v[142:145], v[142:145], v[146:149]
    s_nop 7
    v_cndmask_b32 v149, v146, v147, vcc
    s_and_b64 exec, 3, s[90:91]
    buffer_store_dwordx2 v[148:149], v14, s[4:7], s82 offen offset:256
    s_and_b64 exec, 3, s[92:93]
    buffer_store_dwordx2 v[148:149], v14, s[4:7], s82 offen offset:256 sc1
    s_mov_b64 exec, -1
GS104:
    v_mov_b32 v7, 0xc0135761
    s_barrier
PG105:
    buffer_load_dword v154, v26, s[4:7], s82 offen offset:0 sc1
    buffer_load_dword v155, v26, s[4:7], s82 offen offset:2304 sc1
    buffer_load_dword v156, v27, s[4:7], s82 offen offset:0 sc1
    buffer_load_dword v157, v27, s[4:7], s82 offen offset:2304 sc1
    buffer_load_dwordx2 v[158:159], v29, s[4:7], s82 offen sc1
    s_sub_u32 s84, s84, 1
    s_cbranch_scc1 L_END
T_Mg2_7:
    s_cbranch_execz T_Mg2_8
PW106:
    s_waitcnt vmcnt(0)
    v_max3_u32 v4, v154, v155, v156
    v_max3_u32 v4, v157, v159, v4
    v_cmp_eq_u32 vcc, -1, v4
    v_add_f32_dpp v150, v158, v158 quad_perm:[1,0,3,2] row_mask:0xf bank_mask:0xf
    v_add_f32_dpp v151, v159, v159 quad_perm:[1,0,3,2] row_mask:0xf bank_mask:0xf
    v_add_f32 v146, v154, v155
    v_add_f32_dpp v150, v150, v150 quad_perm:[2,3,0,1] row_mask:0xf bank_mask:0xf
    v_add_f32_dpp v151, v151, v151 quad_perm:[2,3,0,1] row_mask:0xf bank_mask:0xf
    s_cbranch_vccnz PG105
    v_mul_f32 v4, 0x3ae38e39, v150
    v_fmamk_f32 v151, v151, 0x3ae38e39, v35
    v_fma_f32 v151, -v4, v4, v151
    v_max_f32 v151, v151, v35
    v_rsq_f32 v5, v151
    v_add_f32 v148, v156, v157
    v_add_f32 v146, v146, v148
    v_fma_f32 v146, -v4, v28, v146
    v_fma_f32 v146, v146, v5, v34
    v_mul_f32 v4, v146, v146
    v_fmamk_f32 v4, v4, 0xbdd2d3e8, v7
    v_mul_f32 v4, v4, v146
    v_exp_f32 v4, v4
    s_nop 0
    v_add_f32 v4, 1.0, v4
    v_rcp_f32 v4, v4
    s_nop 0
    v_mul_f32 v146, v146, v4
    v_cvt_pk_bf16_f32 v146, v146, v146
    ds_write_b16 v30, v146
    ds_read_b128 v[150:153], v31
    s_waitcnt lgkmcnt(0)
    v_mfma_f32_16x16x32_bf16 v[126:129], v[150:153], v[106:109], 0
    v_mfma_f32_16x16x32_bf16 v[130:133], v[150:153], v[110:113], 0
    v_mfma_f32_16x16x32_bf16 v[134:137], v[150:153], v[114:117], 0
    v_mfma_f32_16x16x32_bf16 v[138:141], v[150:153], v[118:121], 0
    v_mfma_f32_16x16x32_bf16 v[142:145], v[150:153], v[122:125], 0
    s_mov_b64 exec, 0xffff
    s_nop 2
    ds_write2st64_b32 v22, v126, v127 offset0:0 offset1:15
    ds_write2st64_b32 v22, v130, v131 offset0:3 offset1:18
    ds_write2st64_b32 v22, v134, v135 offset0:6 offset1:21
    ds_write2st64_b32 v22, v138, v139 offset0:9 offset1:24
    ds_write2st64_b32 v22, v142, v143 offset0:12 offset1:27
    s_mov_b64 exec, -1
    s_waitcnt lgkmcnt(0)
    s_barrier
    s_barrier
    s_and_b32 s85, s2, 63
    s_cbranch_scc0 GO107
    s_endpgm
GO107:
    v_and_b32 v4, 1, v1
    v_mul_u32_u24 v4, 832, v4
    s_mul_i32 s85, s78, 288
    v_add3_u32 v9, v9, v4, s85
    s_mov_b32 s83, 1441792
    s_barrier
    s_mov_b64 vcc, -1
XG108:
    s_mov_b64 exec, vcc
    buffer_load_dwordx4 v[154:157], v8, s[4:7], s83 offen sc1
    s_mov_b64 exec, -1
    s_sub_u32 s84, s84, 1
    s_cbranch_scc1 L_END
T_Mg2_8:
    s_cbranch_execz T_Mg2_9
    s_waitcnt vmcnt(0)
XW109:
    v_mfma_f32_16x16x32_bf16 v[146:149], v[154:157], v[164:167], 0
    v_max3_u32 v4, v154, v155, v156
    v_max_u32 v4, v4, v157
    v_cmp_eq_u32 vcc, -1, v4
    s_nop 1
    s_cbranch_vccnz XG108
    s_nop 1
    v_permlane32_swap_b32 v146, v147
    v_permlane32_swap_b32 v148, v149
    v_add_f32 v146, v146, v147
    v_add_f32 v148, v148, v149
    s_nop 1
    v_permlane16_swap_b32 v146, v148
    v_add_f32 v146, v146, v32
    v_add_f32 v146, v146, v148
    v_cvt_pk_bf16_f32 v146, v146, v146
    buffer_store_short v146, v9, s[8:11], 0 offen
    s_endpgm
T_Mg2_9:
    s_branch U_Mg2
    .p2align 12
T_Max:
    s_branch T_Max_1
B_Max:
    s_waitcnt lgkmcnt(0)
    s_barrier
    s_barrier
    ds_read_b128 v[142:145], v20 offset:44800
    s_waitcnt lgkmcnt(0)
    v_max3_f32 v4, v142, v143, v144
    v_max_f32 v150, v4, v145
    s_barrier
    ds_read_b64 v[146:147], v14 offset:44160
    s_waitcnt lgkmcnt(0)
    v_lshlrev_b32 v148, 16, v146
    v_and_b32 v146, 0xffff0000, v146
    v_lshlrev_b32 v149, 16, v147
    v_and_b32 v147, 0xffff0000, v147
    v_pk_add_f32 v[146:147], v[146:147], v[148:149]
    v_add_f32 v151, v146, v147
    s_nop 1
    v_add_f32_dpp v151, v151, v151 row_ror:8 row_mask:0xf bank_mask:0xf
    s_nop 1
    v_add_f32_dpp v151, v151, v151 row_ror:4 row_mask:0xf bank_mask:0xf
    s_nop 1
    v_add_f32_dpp v151, v151, v151 row_ror:2 row_mask:0xf bank_mask:0xf
    s_nop 1
    v_add_f32_dpp v151, v151, v151 row_ror:1 row_mask:0xf bank_mask:0xf
    v_mov_b32 v4, v151
    s_nop 1
    v_permlane16_swap_b32 v151, v4
    v_add_f32 v151, v151, v4
    s_and_b64 exec, s[98:99], s[90:91]
    buffer_store_dwordx2 v[150:151], v12, s[4:7], s81 offen
    s_and_b64 exec, s[98:99], s[92:93]
    buffer_store_dwordx2 v[150:151], v12, s[4:7], s81 offen sc1
    s_mov_b64 exec, -1
    s_barrier
    s_barrier
    s_mul_i32 s85, s77, 1792
    s_add_u32 s85, s85, s81
    s_add_u32 s85, s85, 71680
    s_and_b64 exec, -1, s[90:91]
    buffer_store_dwordx4 v[36:39], v40, s[4:7], s85 offen offset:0
    s_and_b64 exec, -1, s[92:93]
    buffer_store_dwordx4 v[36:39], v40, s[4:7], s85 offen offset:0 sc1
    s_mov_b64 exec, -1
    s_and_b64 exec, -1, s[90:91]
    buffer_store_dwordx4 v[36:39], v40, s[4:7], s85 offen offset:768
    s_and_b64 exec, -1, s[92:93]
    buffer_store_dwordx4 v[36:39], v40, s[4:7], s85 offen offset:768 sc1
    s_mov_b64 exec, -1
    s_mul_i32 s85, s88, 1152
    s_add_u32 s85, s85, s81
    s_add_u32 s85, s85, 27648
    v_lshlrev_b32 v4, 7, v1
    s_mov_b64 exec, 511
    buffer_load_dword v41, v4, s[4:7], s85 offen offset:0 sc1
    s_mov_b64 exec, -1
    s_mul_i32 s85, s88, 640
    s_add_u32 s85, s85, s81
    s_add_u32 s85, s85, 62464
    v_lshlrev_b32 v4, 7, v1
    s_mov_b64 exec, 31
    buffer_load_dword v41, v4, s[4:7], s85 offen offset:0 sc1
    s_mov_b64 exec, -1
    s_add_u32 s85, s81, 24832
    v_lshlrev_b32 v4, 7, v1
    s_mov_b64 exec, 3
    buffer_load_dword v41, v4, s[4:7], s85 offen offset:0 sc1
    s_mov_b64 exec, -1
    s_waitcnt vmcnt(0)
    s_load_dwordx8 s[24:31], s[46:47], 128
    v_and_b32 v5, 28, v42
    s_waitcnt lgkmcnt(0)
    s_and_b64 s[24:25], s[24:25], s[26:27]
    s_and_b64 s[28:29], s[28:29], s[30:31]
    s_and_b64 s[24:25], s[24:25], s[28:29]
    s_cmp_eq_u64 s[24:25], -1
    s_cbranch_scc1 FK117
FG116:
    buffer_load_dword v4, v5, s[12:15], 0 offen offset:128 sc1
    s_sub_u32 s84, s84, 1
    s_cbranch_scc1 L_END
T_Max_1:
    s_cbranch_execz T_Max_2
    s_waitcnt vmcnt(0)
    v_cmp_ne_u32 vcc, -1, v4
    s_cbranch_vccnz FG116
FK117:
    s_waitcnt lgkmcnt(0)
    s_barrier
    v_mov_b32 v142, 0
    v_mov_b32 v143, 0
    v_mov_b32 v4, 44872
    ds_read_b64 v[152:153], v4
    v_or_b32 v5, 8192, v8
    v_and_b32 v8, 0xffffdfff, v8
    s_waitcnt lgkmcnt(0)
    v_cmp_lt_u32 vcc, v153, v152
    s_nop 1
    v_cndmask_b32 v8, v8, v5, vcc
    s_mov_b32 s83, 1048576
    buffer_load_dwordx4 v[154:157], v8, s[4:7], s83 offen sc1
    ds_read_b64_tr_b16 v[88:89], v89 offset:39680
    ds_read_b64_tr_b16 v[90:91], v105 offset:21248
    ds_read_b64_tr_b16 v[92:93], v105 offset:21824
    ds_read_b64_tr_b16 v[94:95], v105 offset:25856
    ds_read_b64_tr_b16 v[96:97], v105 offset:26432
    ds_read_b64_tr_b16 v[98:99], v105 offset:30464
    ds_read_b64_tr_b16 v[100:101], v105 offset:31040
    ds_read_b64_tr_b16 v[102:103], v105 offset:35072
    ds_read_b64_tr_b16 v[104:105], v105 offset:35648
    ds_read_b128 v[126:129], v10 offset:42496
    ds_read_b128 v[130:133], v10 offset:42560
    ds_read_b128 v[134:137], v10 offset:42624
    ds_read_b128 v[138:141], v10 offset:42688
    ds_read_b64 v[144:145], v11 offset:42752
    s_waitcnt lgkmcnt(4)
    v_mfma_f32_16x16x32_bf16 v[146:149], v[90:93], v[126:129], 0
    s_waitcnt lgkmcnt(3)
    v_mfma_f32_16x16x32_bf16 v[146:149], v[94:97], v[130:133], v[146:149]
    s_waitcnt lgkmcnt(2)
    v_mfma_f32_16x16x32_bf16 v[146:149], v[98:101], v[134:137], v[146:149]
    s_waitcnt lgkmcnt(1)
    v_mfma_f32_16x16x32_bf16 v[146:149], v[102:105], v[138:141], v[146:149]
    s_waitcnt lgkmcnt(0)
    v_mfma_f32_16x16x32_bf16 v[146:149], v[86:89], v[142:145], v[146:149]
    s_andn2_b64 s[94:95], s[94:95], s[96:97]
    s_and_b64 exec, s[94:95], s[90:91]
    s_nop 5
    buffer_store_dwordx4 v[146:149], v13, s[4:7], s81 offen
    s_and_b64 exec, s[94:95], s[92:93]
    buffer_store_dwordx4 v[146:149], v13, s[4:7], s81 offen sc1
    s_mov_b64 exec, -1
    ds_read_b64_tr_b16 v[106:107], v125 offset:0
    ds_read_b64_tr_b16 v[108:109], v125 offset:576
    ds_read_b64_tr_b16 v[110:111], v125 offset:32
    ds_read_b64_tr_b16 v[112:113], v125 offset:608
    ds_read_b64_tr_b16 v[114:115], v125 offset:64
    ds_read_b64_tr_b16 v[116:117], v125 offset:640
    ds_read_b64_tr_b16 v[118:119], v125 offset:96
    ds_read_b64_tr_b16 v[120:121], v125 offset:672
    ds_read_b64_tr_b16 v[122:123], v125 offset:128
    ds_read_b64_tr_b16 v[124:125], v125 offset:704
    s_waitcnt vmcnt(0)
    s_branch XW119
XG118:
    s_mov_b64 exec, vcc
    buffer_load_dwordx4 v[154:157], v8, s[4:7], s83 offen sc1
    s_mov_b64 exec, -1
    s_sub_u32 s84, s84, 1
    s_cbranch_scc1 L_END
T_Max_2:
    s_cbranch_execz T_Max_3
    s_waitcnt vmcnt(0)
XW119:
    v_mfma_f32_16x16x32_bf16 v[146:149], v[154:157], v[164:167], 0
    v_max3_u32 v4, v154, v155, v156
    v_max_u32 v4, v4, v157
    v_cmp_eq_u32 vcc, -1, v4
    s_nop 1
    s_cbranch_vccnz XG118
    s_nop 1
    v_permlane32_swap_b32 v146, v147
    v_permlane32_swap_b32 v148, v149
    v_add_f32 v146, v146, v147
    v_add_f32 v148, v148, v149
    s_nop 1
    v_permlane16_swap_b32 v146, v148
    v_add_f32 v146, v146, v32
    v_add_f32 v146, v146, v148
    v_cvt_pk_bf16_f32 v146, v146, v146
    ds_write_b16 v9, v146 offset:42496
    v_lshlrev_b32 v32, 16, v146
    v_add_f32 v32, v32, v33
    s_add_u32 s85, s81, 4608
    buffer_load_dword v160, v28, s[4:7], s81 offen offset:0 sc1
    buffer_load_dword v161, v28, s[4:7], s81 offen offset:2304 sc1
    buffer_load_dword v162, v28, s[4:7], s85 offen offset:0 sc1
    buffer_load_dword v163, v28, s[4:7], s85 offen offset:2304 sc1
    s_waitcnt lgkmcnt(0)
    s_barrier
    ds_read_b128 v[126:129], v10 offset:42496
    ds_read_b128 v[130:133], v10 offset:42560
    ds_read_b128 v[134:137], v10 offset:42624
    ds_read_b128 v[138:141], v10 offset:42688
    ds_read_b64 v[144:145], v11 offset:42752
    s_waitcnt lgkmcnt(4)
    v_mfma_f32_16x16x32_bf16 v[146:149], v[90:93], v[126:129], 0
    s_waitcnt lgkmcnt(3)
    v_mfma_f32_16x16x32_bf16 v[146:149], v[94:97], v[130:133], v[146:149]
    s_waitcnt lgkmcnt(2)
    v_mfma_f32_16x16x32_bf16 v[146:149], v[98:101], v[134:137], v[146:149]
    s_waitcnt lgkmcnt(1)
    v_mfma_f32_16x16x32_bf16 v[146:149], v[102:105], v[138:141], v[146:149]
    s_waitcnt lgkmcnt(0)
    v_mfma_f32_16x16x32_bf16 v[146:149], v[86:89], v[142:145], v[146:149]
    s_and_b64 exec, s[96:97], s[90:91]
    s_nop 6
    buffer_store_dwordx4 v[146:149], v13, s[4:7], s81 offen
    s_and_b64 exec, s[96:97], s[92:93]
    buffer_store_dwordx4 v[146:149], v13, s[4:7], s81 offen sc1
    s_mov_b64 exec, -1
    v_mov_b32 v7, 0xc0135761
    s_barrier
    buffer_load_dword v154, v26, s[4:7], s81 offen offset:0 sc1
    buffer_load_dword v155, v26, s[4:7], s81 offen offset:2304 sc1
    buffer_load_dword v156, v27, s[4:7], s81 offen offset:0 sc1
    buffer_load_dword v157, v27, s[4:7], s81 offen offset:2304 sc1
    buffer_load_dwordx2 v[158:159], v29, s[4:7], s81 offen sc1
    s_waitcnt vmcnt(5)
    s_branch CW123
CG122:
    s_add_u32 s85, s81, 4608
    buffer_load_dword v160, v28, s[4:7], s81 offen offset:0 sc1
    buffer_load_dword v161, v28, s[4:7], s81 offen offset:2304 sc1
    buffer_load_dword v162, v28, s[4:7], s85 offen offset:0 sc1
    buffer_load_dword v163, v28, s[4:7], s85 offen offset:2304 sc1
    s_sub_u32 s84, s84, 1
    s_cbranch_scc1 L_END
T_Max_3:
    s_cbranch_execz T_Max_4
    s_waitcnt vmcnt(0)
CW123:
    v_max3_u32 v4, v160, v161, v162
    v_max_u32 v4, v4, v163
    v_cmp_eq_u32 vcc, -1, v4
    v_add_f32 v4, v160, v161
    v_add_f32 v5, v162, v163
    s_cbranch_vccnz CG122
    v_add_f32 v28, v4, v5
    s_branch PW121
PG120:
    buffer_load_dword v154, v26, s[4:7], s81 offen offset:0 sc1
    buffer_load_dword v155, v26, s[4:7], s81 offen offset:2304 sc1
    buffer_load_dword v156, v27, s[4:7], s81 offen offset:0 sc1
    buffer_load_dword v157, v27, s[4:7], s81 offen offset:2304 sc1
    buffer_load_dwordx2 v[158:159], v29, s[4:7], s81 offen sc1
    s_sub_u32 s84, s84, 1
    s_cbranch_scc1 L_END
T_Max_4:
    s_cbranch_execz T_Max_5
PW121:
    s_waitcnt vmcnt(0)
    v_max3_u32 v4, v154, v155, v156
    v_max3_u32 v4, v157, v159, v4
    v_cmp_eq_u32 vcc, -1, v4
    v_add_f32_dpp v150, v158, v158 quad_perm:[1,0,3,2] row_mask:0xf bank_mask:0xf
    v_add_f32_dpp v151, v159, v159 quad_perm:[1,0,3,2] row_mask:0xf bank_mask:0xf
    v_add_f32 v146, v154, v155
    v_add_f32_dpp v150, v150, v150 quad_perm:[2,3,0,1] row_mask:0xf bank_mask:0xf
    v_add_f32_dpp v151, v151, v151 quad_perm:[2,3,0,1] row_mask:0xf bank_mask:0xf
    s_cbranch_vccnz PG120
    v_mul_f32 v4, 0x3ae38e39, v150
    v_fmamk_f32 v151, v151, 0x3ae38e39, v35
    v_fma_f32 v151, -v4, v4, v151
    v_max_f32 v151, v151, v35
    v_rsq_f32 v5, v151
    v_add_f32 v148, v156, v157
    v_add_f32 v146, v146, v148
    v_fma_f32 v146, -v4, v28, v146
    v_fma_f32 v146, v146, v5, v34
    v_mul_f32 v4, v146, v146
    v_fmamk_f32 v4, v4, 0xbdd2d3e8, v7
    v_mul_f32 v4, v4, v146
    v_exp_f32 v4, v4
    s_nop 0
    v_add_f32 v4, 1.0, v4
    v_rcp_f32 v4, v4
    s_nop 0
    v_mul_f32 v146, v146, v4
    v_cvt_pk_bf16_f32 v146, v146, v146
    ds_write_b16 v30, v146
    ds_read_b128 v[150:153], v31
    s_waitcnt lgkmcnt(0)
    v_mfma_f32_16x16x32_bf16 v[126:129], v[150:153], v[106:109], 0
    v_mfma_f32_16x16x32_bf16 v[130:133], v[150:153], v[110:113], 0
    v_mfma_f32_16x16x32_bf16 v[134:137], v[150:153], v[114:117], 0
    v_mfma_f32_16x16x32_bf16 v[138:141], v[150:153], v[118:121], 0
    v_mfma_f32_16x16x32_bf16 v[142:145], v[150:153], v[122:125], 0
    s_mov_b64 exec, 0xffff
    s_nop 2
    ds_write2st64_b32 v22, v126, v127 offset0:0 offset1:15
    ds_write2st64_b32 v22, v130, v131 offset0:3 offset1:18
    ds_write2st64_b32 v22, v134, v135 offset0:6 offset1:21
    ds_write2st64_b32 v22, v138, v139 offset0:9 offset1:24
    ds_write2st64_b32 v22, v142, v143 offset0:12 offset1:27
    s_mov_b64 exec, -1
    s_waitcnt lgkmcnt(0)
    s_barrier
    s_barrier
    v_mov_b32 v144, 0
    v_mov_b32 v145, 0
    s_mov_b32 s83, 1179648
    s_mov_b64 exec, 1
HW124:
    buffer_load_dword v4, off, s[4:7], s80 offset:1024 sc1
    s_sub_u32 s84, s84, 1
    s_cbranch_scc1 L_END
T_Max_5:
    s_cbranch_execz T_Max_6
    s_waitcnt vmcnt(0)
    v_cmp_eq_u32 vcc, -1, v4
    s_cbranch_vccnz HW124
    s_mov_b64 exec, -1
    s_barrier
    s_add_u32 s80, s80, 63488
    s_mov_b64 vcc, -1
XG125:
    s_mov_b64 exec, vcc
    buffer_load_dwordx4 v[154:157], v8, s[4:7], s83 offen sc1
    s_mov_b64 exec, -1
    s_sub_u32 s84, s84, 1
    s_cbranch_scc1 L_END
T_Max_6:
    s_cbranch_execz T_Max_7
    s_waitcnt vmcnt(0)
XW126:
    v_mfma_f32_16x16x32_bf16 v[146:149], v[154:157], v[164:167], 0
    v_max3_u32 v4, v154, v155, v156
    v_max_u32 v4, v4, v157
    v_cmp_eq_u32 vcc, -1, v4
    s_nop 1
    s_cbranch_vccnz XG125
    s_nop 1
    v_permlane32_swap_b32 v146, v147
    v_permlane32_swap_b32 v148, v149
    v_add_f32 v146, v146, v147
    v_add_f32 v148, v148, v149
    s_nop 1
    v_permlane16_swap_b32 v146, v148
    v_add_f32 v146, v146, v32
    v_add_f32 v146, v146, v148
    v_cvt_pk_bf16_f32 v146, v146, v146
    ds_write_b16 v9, v146 offset:42496
    v_lshlrev_b32 v32, 16, v146
    s_waitcnt lgkmcnt(0)
    s_barrier
    s_barrier
    s_waitcnt lgkmcnt(0)
    s_barrier
    s_barrier
    ds_read_b128 v[142:145], v20 offset:44832
    s_waitcnt lgkmcnt(0)
    v_max3_f32 v4, v142, v143, v144
    v_max_f32 v150, v4, v145
    s_barrier
    ds_read_b64 v[146:147], v14 offset:44160
    s_waitcnt lgkmcnt(0)
    v_lshlrev_b32 v148, 16, v146
    v_and_b32 v146, 0xffff0000, v146
    v_lshlrev_b32 v149, 16, v147
    v_and_b32 v147, 0xffff0000, v147
    v_pk_add_f32 v[146:147], v[146:147], v[148:149]
    v_add_f32 v151, v146, v147
    s_nop 1
    v_add_f32_dpp v151, v151, v151 row_ror:8 row_mask:0xf bank_mask:0xf
    s_nop 1
    v_add_f32_dpp v151, v151, v151 row_ror:4 row_mask:0xf bank_mask:0xf
    s_nop 1
    v_add_f32_dpp v151, v151, v151 row_ror:2 row_mask:0xf bank_mask:0xf
    s_nop 1
    v_add_f32_dpp v151, v151, v151 row_ror:1 row_mask:0xf bank_mask:0xf
    v_mov_b32 v4, v151
    s_nop 1
    v_permlane16_swap_b32 v151, v4
    v_add_f32 v151, v151, v4
    s_and_b64 exec, s[98:99], s[90:91]
    buffer_store_dwordx2 v[150:151], v12, s[4:7], s82 offen
    s_and_b64 exec, s[98:99], s[92:93]
    buffer_store_dwordx2 v[150:151], v12, s[4:7], s82 offen sc1
    s_mov_b64 exec, -1
    s_barrier
    v_mov_b32 v142, 0
    v_mov_b32 v143, 0
    s_mov_b32 s83, 1310720
    s_mov_b64 exec, 1
HW127:
    buffer_load_dword v4, off, s[4:7], s80 offset:0 sc1
    s_sub_u32 s84, s84, 1
    s_cbranch_scc1 L_END
T_Max_7:
    s_cbranch_execz T_Max_8
    s_waitcnt vmcnt(0)
    v_cmp_eq_u32 vcc, -1, v4
    s_cbranch_vccnz HW127
    s_mov_b64 exec, -1
    v_mov_b32 v4, 44872
    ds_read_b64 v[152:153], v4
    v_or_b32 v5, 8192, v8
    v_and_b32 v8, 0xffffdfff, v8
    s_waitcnt lgkmcnt(0)
    v_cmp_lt_u32 vcc, v153, v152
    s_nop 1
    v_cndmask_b32 v8, v8, v5, vcc
    s_mov_b64 vcc, -1
XG128:
    s_mov_b64 exec, vcc
    buffer_load_dwordx4 v[154:157], v8, s[4:7], s83 offen sc1
    s_mov_b64 exec, -1
    s_sub_u32 s84, s84, 1
    s_cbranch_scc1 L_END
T_Max_8:
    s_cbranch_execz T_Max_9
    s_waitcnt vmcnt(0)
XW129:
    v_mfma_f32_16x16x32_bf16 v[146:149], v[154:157], v[164:167], 0
    v_max3_u32 v4, v154, v155, v156
    v_max_u32 v4, v4, v157
    v_cmp_eq_u32 vcc, -1, v4
    s_nop 1
    s_cbranch_vccnz XG128
    s_nop 1
    v_permlane32_swap_b32 v146, v147
    v_permlane32_swap_b32 v148, v149
    v_add_f32 v146, v146, v147
    v_add_f32 v148, v148, v149
    s_nop 1
    v_permlane16_swap_b32 v146, v148
    v_add_f32 v146, v146, v32
    v_add_f32 v146, v146, v148
    v_cvt_pk_bf16_f32 v146, v146, v146
    ds_write_b16 v9, v146 offset:42496
    v_lshlrev_b32 v32, 16, v146
    v_add_f32 v32, v32, v33
    s_waitcnt lgkmcnt(0)
    s_barrier
    ds_read_b128 v[126:129], v10 offset:42496
    ds_read_b128 v[130:133], v10 offset:42560
    ds_read_b128 v[134:137], v10 offset:42624
    ds_read_b128 v[138:141], v10 offset:42688
    ds_read_b64 v[144:145], v11 offset:42752
    s_waitcnt lgkmcnt(4)
    v_mfma_f32_16x16x32_bf16 v[146:149], v[90:93], v[126:129], 0
    s_waitcnt lgkmcnt(3)
    v_mfma_f32_16x16x32_bf16 v[146:149], v[94:97], v[130:133], v[146:149]
    s_waitcnt lgkmcnt(2)
    v_mfma_f32_16x16x32_bf16 v[146:149], v[98:101], v[134:137], v[146:149]
    s_waitcnt lgkmcnt(1)
    v_mfma_f32_16x16x32_bf16 v[146:149], v[102:105], v[138:141], v[146:149]
    s_waitcnt lgkmcnt(0)
    v_mfma_f32_16x16x32_bf16 v[146:149], v[86:89], v[142:145], v[146:149]
    s_and_b64 exec, s[96:97], s[90:91]
    s_nop 6
    buffer_store_dwordx4 v[146:149], v13, s[4:7], s82 offen
    s_and_b64 exec, s[96:97], s[92:93]
    buffer_store_dwordx4 v[146:149], v13, s[4:7], s82 offen sc1
    s_mov_b64 exec, -1
    v_mov_b32 v7, 0xc0135761
    s_barrier
PG130:
    buffer_load_dword v154, v26, s[4:7], s82 offen offset:0 sc1
    buffer_load_dword v155, v26, s[4:7], s82 offen offset:2304 sc1
    buffer_load_dword v156, v27, s[4:7], s82 offen offset:0 sc1
    buffer_load_dword v157, v27, s[4:7], s82 offen offset:2304 sc1
    buffer_load_dwordx2 v[158:159], v29, s[4:7], s82 offen sc1
    s_sub_u32 s84, s84, 1
    s_cbranch_scc1 L_END
T_Max_9:
    s_cbranch_execz T_Max_10
PW131:
    s_waitcnt vmcnt(0)
    v_max3_u32 v4, v154, v155, v156
    v_max3_u32 v4, v157, v159, v4
    v_cmp_eq_u32 vcc, -1, v4
    v_add_f32_dpp v150, v158, v158 quad_perm:[1,0,3,2] row_mask:0xf bank_mask:0xf
    v_add_f32_dpp v151, v159, v159 quad_perm:[1,0,3,2] row_mask:0xf bank_mask:0xf
    v_add_f32 v146, v154, v155
    v_add_f32_dpp v150, v150, v150 quad_perm:[2,3,0,1] row_mask:0xf bank_mask:0xf
    v_add_f32_dpp v151, v151, v151 quad_perm:[2,3,0,1] row_mask:0xf bank_mask:0xf
    s_cbranch_vccnz PG130
    v_mul_f32 v4, 0x3ae38e39, v150
    v_fmamk_f32 v151, v151, 0x3ae38e39, v35
    v_fma_f32 v151, -v4, v4, v151
    v_max_f32 v151, v151, v35
    v_rsq_f32 v5, v151
    v_add_f32 v148, v156, v157
    v_add_f32 v146, v146, v148
    v_fma_f32 v146, -v4, v28, v146
    v_fma_f32 v146, v146, v5, v34
    v_mul_f32 v4, v146, v146
    v_fmamk_f32 v4, v4, 0xbdd2d3e8, v7
    v_mul_f32 v4, v4, v146
    v_exp_f32 v4, v4
    s_nop 0
    v_add_f32 v4, 1.0, v4
    v_rcp_f32 v4, v4
    s_nop 0
    v_mul_f32 v146, v146, v4
    v_cvt_pk_bf16_f32 v146, v146, v146
    ds_write_b16 v30, v146
    ds_read_b128 v[150:153], v31
    s_waitcnt lgkmcnt(0)
    v_mfma_f32_16x16x32_bf16 v[126:129], v[150:153], v[106:109], 0
    v_mfma_f32_16x16x32_bf16 v[130:133], v[150:153], v[110:113], 0
    v_mfma_f32_16x16x32_bf16 v[134:137], v[150:153], v[114:117], 0
    v_mfma_f32_16x16x32_bf16 v[138:141], v[150:153], v[118:121], 0
    v_mfma_f32_16x16x32_bf16 v[142:145], v[150:153], v[122:125], 0
    s_mov_b64 exec, 0xffff
    s_nop 2
    ds_write2st64_b32 v22, v126, v127 offset0:0 offset1:15
    ds_write2st64_b32 v22, v130, v131 offset0:3 offset1:18
    ds_write2st64_b32 v22, v134, v135 offset0:6 offset1:21
    ds_write2st64_b32 v22, v138, v139 offset0:9 offset1:24
    ds_write2st64_b32 v22, v142, v143 offset0:12 offset1:27
    s_mov_b64 exec, -1
    s_waitcnt lgkmcnt(0)
    s_barrier
    s_barrier
    s_and_b32 s85, s2, 63
    s_cbranch_scc0 GO132
    s_endpgm
GO132:
    v_and_b32 v4, 1, v1
    v_mul_u32_u24 v4, 832, v4
    s_mul_i32 s85, s78, 288
    v_add3_u32 v9, v9, v4, s85
    s_mov_b32 s83, 1441792
    s_mov_b64 exec, 1
HW133:
    buffer_load_dword v4, off, s[4:7], s80 offset:1024 sc1
    s_sub_u32 s84, s84, 1
    s_cbranch_scc1 L_END
T_Max_10:
    s_cbranch_execz T_Max_11
    s_waitcnt vmcnt(0)
    v_cmp_eq_u32 vcc, -1, v4
    s_cbranch_vccnz HW133
    s_mov_b64 exec, -1
    s_barrier
    s_mov_b64 vcc, -1
XG134:
    s_mov_b64 exec, vcc
    buffer_load_dwordx4 v[154:157], v8, s[4:7], s83 offen sc1
    s_mov_b64 exec, -1
    s_sub_u32 s84, s84, 1
    s_cbranch_scc1 L_END
T_Max_11:
    s_cbranch_execz T_Max_12
    s_waitcnt vmcnt(0)
XW135:
    v_mfma_f32_16x16x32_bf16 v[146:149], v[154:157], v[164:167], 0
    v_max3_u32 v4, v154, v155, v156
    v_max_u32 v4, v4, v157
    v_cmp_eq_u32 vcc, -1, v4
    s_nop 1
    s_cbranch_vccnz XG134
    s_nop 1
    v_permlane32_swap_b32 v146, v147
    v_permlane32_swap_b32 v148, v149
    v_add_f32 v146, v146, v147
    v_add_f32 v148, v148, v149
    s_nop 1
    v_permlane16_swap_b32 v146, v148
    v_add_f32 v146, v146, v32
    v_add_f32 v146, v146, v148
    v_cvt_pk_bf16_f32 v146, v146, v146
    buffer_store_short v146, v9, s[8:11], 0 offen
    s_endpgm
T_Max_12:
    s_branch U_Max
L_CODE_END:
    .fill 64, 4, 0xbf810000
.section .rodata,"a"
.p2align 6
.amdhsa_kernel interleave_layers__sliding_block_cached__dense_activation_gelu__decode_kernel
  .amdhsa_next_free_vgpr 168
  .amdhsa_next_free_sgpr 102
  .amdhsa_accum_offset 168
  .amdhsa_group_segment_fixed_size 0
  .amdhsa_kernarg_size 104
  .amdhsa_user_sgpr_count 2
  .amdhsa_user_sgpr_kernarg_segment_ptr 1
  .amdhsa_system_sgpr_workgroup_id_x 1
.end_amdhsa_kernel
```
